```python
import torch

def _softmax(x, axis=-1):
    return torch.softmax(x, dim=axis)
def _gelu(x):
    return torch.nn.functional.gelu(x, approximate="tanh")
def _silu(x):
    return torch.nn.functional.silu(x)
def _sigmoid(x):
    return torch.sigmoid(x)
def _layernorm(x, axis=-1, eps=1e-5):
    m = x.mean(dim=axis, keepdim=True)
    v = x.var(dim=axis, keepdim=True, unbiased=False)
    return (x - m) / torch.sqrt(v + eps)
def _scatter_add(tgt, idx, src, axis=0):
    return tgt.clone().index_add_(axis, idx, src)
def _segment_sum(src, seg, n):
    out = torch.zeros((n,) + src.shape[1:], dtype=src.dtype)
    return out.index_add_(0, seg, src)
def _pad(x, pw):
    flat = tuple(v for pair in reversed(pw) for v in pair)
    return torch.nn.functional.pad(x, flat)

kernel_name = 'standalone__gqa_block_cached__near_ridge'

def setup_inputs():

    _w = (lambda a: (lambda t: t.to(torch.bfloat16) if t.is_floating_point() else t)(torch.as_tensor(a)))
    B, Sq, D = 8, 64, 448
    Hq, Hkv, Sk, Dh = 16, 8, 1024, 256
    assert Hq % Hkv == 0, (Hq, Hkv)
    return {
        "x": _w((lambda *s: torch.randn(*s, dtype=torch.bfloat16) * 0.8)(B, Sq, D)),
        "k_cache": _w((lambda *s: torch.randn(*s, dtype=torch.bfloat16) * 0.8)(B, Hkv, Sk, Dh)),
        "v_cache": _w((lambda *s: torch.randn(*s, dtype=torch.bfloat16) * 0.05)(B, Hkv, Sk, Dh)),
        "wq": _w((lambda *s: torch.randn(*s, dtype=torch.bfloat16) * 0.8)(D, Hq * Dh) * (D ** -0.5)),
        "wo": _w((lambda *s: torch.randn(*s, dtype=torch.bfloat16) * 0.05)(Hq * Dh, D) * ((Hq * Dh) ** -0.5)),
    }

def reference(x, k_cache, v_cache, wq, wo):
    B, Sq, D = x.shape
    Hq, Dh = 16, 256
    Hkv = k_cache.shape[1]
    rep = Hq // Hkv
    q = (lambda x, *d: x.permute(*d))((x @ wq).reshape(B, Sq, Hq, Dh), 0, 2, 1, 3)
    k = (lambda x, n, axis: torch.repeat_interleave(x, n, dim=axis))(k_cache, rep, axis=1)
    v = (lambda x, n, axis: torch.repeat_interleave(x, n, dim=axis))(v_cache, rep, axis=1)
    scores = torch.einsum("bhqd,bhkd->bhqk", q, k) * (Dh ** -0.5)
    p = _softmax(scores, axis=-1)
    o = torch.einsum("bhqk,bhkd->bhqd", p, v)
    return (lambda x, *d: x.permute(*d))(o, 0, 2, 1, 3).reshape(B, Sq, Hq * Dh) @ wo
```

```asm
; @launch grid=(256,1,1) block=(512,1,1) lds=163840
.amdgcn_target "amdgcn-amd-amdhsa--gfx950"
.text
.globl standalone__gqa_block_cached__near_ridge_kernel
.p2align 8
.type standalone__gqa_block_cached__near_ridge_kernel,@function
standalone__gqa_block_cached__near_ridge_kernel:
    s_cmp_ge_u32 s2, 256
    s_cbranch_scc1 Lexit
    s_load_dwordx8 s[4:11], s[0:1], 0
    s_load_dwordx8 s[12:19], s[0:1], 32
    s_getpc_b64 s[60:61]
Lpc:
    s_bfe_u32 s62, s2, 196611
    s_mul_i32 s62, s62, 8192
    v_lshrrev_b32 v8, 3, v0
    v_lshl_add_u32 v8, v8, 7, s62
    v_min_u32 v8, Lcode_end-Lpc-4, v8
    global_load_dword v3, v8, s[60:61]
    v_lshrrev_b32 v1, 6, v0
    s_and_b32 s20, s2, 7
    v_readfirstlane_b32 s24, v1
    v_and_b32 v2, 255, v0
    v_and_b32 v0, 63, v0
    v_lshlrev_b32 v2, 2, v2
    v_add_u32 v2, 155648, v2
    v_mov_b32 v4, 0
    v_mov_b32 v6, 0
    v_mov_b32 v7, 0
    s_lshr_b32 s60, s2, 3
    s_and_b32 s22, s60, 3
    s_lshr_b32 s21, s60, 2
    s_lshl_b32 s25, s20, 5
    s_add_u32 s25, s25, s60
    s_and_b32 s23, s24, 3
    s_mov_b32 s28, 0x40000
    s_mov_b32 s30, 0
    s_lshl_b32 s3, s21, 7
    s_cmp_lt_u32 s24, 4
    s_cbranch_scc1 Lcompute
Lhelper:
    ds_write_b32 v2, v4 offset:0
    ds_write_b32 v2, v4 offset:1024
    ds_write_b32 v2, v4 offset:2048
    v_lshrrev_b32 v20, 3, v0
    v_and_b32 v21, 7, v0
    v_lshrrev_b32 v22, 4, v0
    s_lshl_b32 s60, s23, 4
    s_lshl_b32 s61, s21, 6
    s_add_u32 s60, s60, s61
    v_add_u32 v23, 0, v20
    v_add_u32 v23, s60, v23
    v_mul_u32_u24 v23, 896, v23
    v_add_u32 v24, 0, v22
    v_xor_b32 v24, v21, v24
    v_lshl_add_u32 v8, v24, 4, v23
    v_add_u32 v23, 8, v20
    v_add_u32 v23, s60, v23
    v_mul_u32_u24 v23, 896, v23
    v_add_u32 v24, 4, v22
    v_xor_b32 v24, v21, v24
    v_lshl_add_u32 v9, v24, 4, v23
    v_lshlrev_b32 v24, 1, v22
    v_xor_b32 v24, v21, v24
    v_lshlrev_b32 v24, 4, v24
    v_lshl_add_u32 v24, v22, 13, v24
    v_bfe_u32 v23, v0, 3, 1
    v_lshl_add_u32 v10, v23, 9, v24
    v_xor_b32 v5, 0x200, v10
    s_lshl_b32 s60, s20, 10
    s_lshl_b32 s61, s22, 7
    s_add_u32 s60, s60, s61
    s_lshl_b32 s61, s23, 17
    s_add_u32 s73, s60, s61
    s_lshl_b32 s24, s23, 11
    s_lshl_b32 s71, s23, 12
    v_mov_b32 v19, 0
    v_lshlrev_b32 v31, 7, v21
    s_lshl_b32 s60, s22, 1
    s_add_u32 s70, s60, s21
    s_cmp_ge_u32 s70, 7
    s_cselect_b32 s60, 7, 0
    s_sub_u32 s70, s70, s60
    s_waitcnt lgkmcnt(0)
    s_mov_b32 s36, s4
    s_and_b32 s37, s5, 0xffff
    s_mov_b32 s38, 458752
    s_mov_b32 s39, 0x00020000
    s_mov_b32 s40, s10
    s_and_b32 s41, s11, 0xffff
    s_mov_b32 s42, 3670016
    s_mov_b32 s43, 0x00020000
    s_getpc_b64 s[16:17]
Lt_167:
    s_add_u32 s16, s16, Ltable-Lt_167
    s_addc_u32 s17, s17, 0
    s_lshl_b32 s0, s23, 8
    s_add_u32 s0, s0, 155648
    s_add_u32 m0, s24, 81920
    s_lshl_b32 s61, s70, 7
    buffer_load_dwordx4 v8, s[36:39], s61 offen  lds
    s_add_u32 m0, s24, 82944
    s_lshl_b32 s61, s70, 7
    buffer_load_dwordx4 v9, s[36:39], s61 offen  lds
    s_lshl_b32 s79, s70, 19
    s_add_u32 s79, s79, s73
    s_add_u32 s70, s70, 1
    s_cmp_eq_u32 s70, 7
    s_cselect_b32 s70, 0, s70
    s_add_u32 m0, s71, 90112
    s_add_u32 s61, s79, 0
    buffer_load_dwordx4 v10, s[40:43], s61 offen  lds
    s_add_u32 m0, s71, 91136
    s_add_u32 s61, s79, 32768
    buffer_load_dwordx4 v10, s[40:43], s61 offen  lds
    s_add_u32 m0, s71, 92160
    s_add_u32 s61, s79, 65536
    buffer_load_dwordx4 v5, s[40:43], s61 offen  lds
    s_add_u32 m0, s71, 93184
    s_add_u32 s61, s79, 98304
    buffer_load_dwordx4 v5, s[40:43], s61 offen  lds
    s_add_u32 m0, s0, -4
    s_nop 0
    global_load_lds_dword v19, s[16:17] offset:4
    s_add_u32 m0, s24, 106496
    s_lshl_b32 s61, s70, 7
    buffer_load_dwordx4 v8, s[36:39], s61 offen  lds
    s_add_u32 m0, s24, 107520
    s_lshl_b32 s61, s70, 7
    buffer_load_dwordx4 v9, s[36:39], s61 offen  lds
    s_load_dwordx2 s[26:27], s[18:19], s3
    s_mov_b32 s32, s18
    s_and_b32 s33, s19, 0xffff
    s_mov_b32 s34, 268435456
    s_mov_b32 s35, 0x00020000
    s_mov_b32 s44, s6
    s_and_b32 s45, s7, 0xffff
    s_mov_b32 s46, 33554432
    s_mov_b32 s47, 0x00020000
    s_mov_b32 s48, s8
    s_and_b32 s49, s9, 0xffff
    s_mov_b32 s50, 33554432
    s_mov_b32 s51, 0x00020000
    s_mov_b32 s52, s12
    s_and_b32 s53, s13, 0xffff
    s_mov_b32 s54, 3670016
    s_mov_b32 s55, 0x00020000
    v_and_b32 v26, 3, v0
    v_lshlrev_b32 v26, 8, v26
    v_lshl_add_u32 v26, v0, 2, v26
    v_add_u32 v1, 155648, v26
    v_lshrrev_b32 v23, 5, v0
    v_and_b32 v24, 31, v0
    s_lshl_b32 s58, s23, 2
    s_lshl_b32 s57, s22, 3
    v_xor_b32 v24, s57, v24
    v_add_u32 v26, 0, v23
    v_add_u32 v26, s58, v26
    v_xor_b32 v27, v24, v26
    v_lshlrev_b32 v11, 4, v27
    v_bfe_u32 v28, v26, 0, 1
    v_mul_u32_u24 v28, 512, v28
    v_add_u32 v11, v11, v28
    v_bfe_u32 v28, v26, 1, 3
    v_mul_u32_u24 v28, 32768, v28
    v_add_u32 v11, v11, v28
    v_add_u32 v26, 2, v23
    v_add_u32 v26, s58, v26
    v_xor_b32 v27, v24, v26
    v_lshlrev_b32 v12, 4, v27
    v_bfe_u32 v28, v26, 0, 1
    v_mul_u32_u24 v28, 512, v28
    v_add_u32 v12, v12, v28
    v_bfe_u32 v28, v26, 1, 3
    v_mul_u32_u24 v28, 32768, v28
    v_add_u32 v12, v12, v28
    v_lshlrev_b32 v26, 1, v22
    v_xor_b32 v26, v21, v26
    v_lshlrev_b32 v13, 4, v26
    v_bfe_u32 v28, v20, 0, 1
    v_mul_u32_u24 v28, 512, v28
    v_add_u32 v13, v13, v28
    v_bfe_u32 v28, v20, 1, 2
    v_mul_u32_u24 v28, 32768, v28
    v_add_u32 v13, v13, v28
    s_lshl_b32 s56, s21, 3
    s_add_u32 s56, s56, s20
    s_lshl_b32 s57, s56, 19
    s_bfe_u32 s56, s22, 65536
    s_mul_i32 s56, s56, 1024
    s_add_u32 s57, s57, s56
    s_bfe_u32 s56, s22, 65537
    s_mul_i32 s56, s56, 4096
    s_add_u32 s57, s57, s56
    s_mul_i32 s58, s21, 3
    s_mul_i32 s56, s22, 3
    s_add_u32 s58, s58, s56
    s_mul_i32 s56, s20, 1
    s_add_u32 s58, s58, s56
    s_bfe_u32 s56, s58, 65536
    s_mul_i32 s56, s56, 2048
    s_add_u32 s62, s57, s56
    s_bfe_u32 s56, s58, 131073
    s_mul_i32 s56, s56, 8192
    s_add_u32 s62, s62, s56
    s_add_u32 s58, s58, 1
    s_bfe_u32 s56, s58, 65536
    s_mul_i32 s56, s56, 2048
    s_add_u32 s63, s57, s56
    s_bfe_u32 s56, s58, 131073
    s_mul_i32 s56, s56, 8192
    s_add_u32 s63, s63, s56
    s_add_u32 s58, s58, 1
    s_bfe_u32 s56, s58, 65536
    s_mul_i32 s56, s56, 2048
    s_add_u32 s64, s57, s56
    s_bfe_u32 s56, s58, 131073
    s_mul_i32 s56, s56, 8192
    s_add_u32 s64, s64, s56
    s_add_u32 s58, s58, 1
    s_bfe_u32 s56, s58, 65536
    s_mul_i32 s56, s56, 2048
    s_add_u32 s65, s57, s56
    s_bfe_u32 s56, s58, 131073
    s_mul_i32 s56, s56, 8192
    s_add_u32 s65, s65, s56
    s_add_u32 s58, s58, 1
    s_bfe_u32 s56, s58, 65536
    s_mul_i32 s56, s56, 2048
    s_add_u32 s66, s57, s56
    s_bfe_u32 s56, s58, 131073
    s_mul_i32 s56, s56, 8192
    s_add_u32 s66, s66, s56
    s_add_u32 s58, s58, 1
    s_bfe_u32 s56, s58, 65536
    s_mul_i32 s56, s56, 2048
    s_add_u32 s67, s57, s56
    s_bfe_u32 s56, s58, 131073
    s_mul_i32 s56, s56, 8192
    s_add_u32 s67, s67, s56
    s_add_u32 s58, s58, 1
    s_bfe_u32 s56, s58, 65536
    s_mul_i32 s56, s56, 2048
    s_add_u32 s68, s57, s56
    s_bfe_u32 s56, s58, 131073
    s_mul_i32 s56, s56, 8192
    s_add_u32 s68, s68, s56
    s_add_u32 s58, s58, 1
    s_bfe_u32 s56, s58, 65536
    s_mul_i32 s56, s56, 2048
    s_add_u32 s69, s57, s56
    s_bfe_u32 s56, s58, 131073
    s_mul_i32 s56, s56, 8192
    s_add_u32 s69, s69, s56
    s_add_u32 s58, s58, 1
    s_cmp_ge_u32 s23, 2
    s_cselect_b32 s74, s63, s62
    s_cselect_b32 s75, s65, s64
    s_cselect_b32 s76, s67, s66
    s_cselect_b32 s77, s69, s68
    s_and_b32 s57, s23, 1
    s_mul_i32 s57, s57, 262144
    s_add_u32 s74, s74, s57
    s_add_u32 s75, s75, s57
    s_add_u32 s76, s76, s57
    s_add_u32 s77, s77, s57
    s_lshl_b32 s31, s22, 8
    s_cmp_eq_u32 s22, 3
    s_cselect_b32 s31, 640, s31
    s_mul_i32 s56, s20, 458752
    s_lshl_b32 s57, s23, 6
    s_add_u32 s56, s56, s57
    s_add_u32 s78, s56, s31
    v_mul_u32_u24 v30, 896, v21
    s_lshr_b32 s56, s23, 1
    s_lshl_b32 s56, s56, 5
    s_lshl_b32 s57, s20, 6
    s_add_u32 s56, s56, s57
    s_add_u32 s56, s56, s21
    s_mul_i32 s56, s56, 7168
    s_and_b32 s57, s23, 1
    s_lshl_b32 s57, s57, 7
    s_add_u32 s56, s56, s57
    s_add_u32 s72, s56, s31
    v_bfe_u32 v26, v0, 2, 3
    v_lshl_add_u32 v26, v23, 4, v26
    v_mul_u32_u24 v26, 896, v26
    v_and_b32 v27, 3, v0
    v_lshl_add_u32 v14, v27, 4, v26
    v_bfe_u32 v26, v0, 2, 2
    v_lshl_add_u32 v27, v23, 2, v26
    v_lshlrev_b32 v27, 6, v27
    v_bfe_u32 v28, v0, 4, 1
    v_lshl_add_u32 v27, v28, 4, v27
    v_and_b32 v28, 1, v0
    v_lshl_add_u32 v27, v28, 5, v27
    v_bfe_u32 v28, v0, 1, 1
    v_lshl_add_u32 v27, v28, 3, v27
    s_mul_i32 s56, s23, 6144
    s_add_u32 s56, s56, 131072
    v_add_u32 v16, s56, v27
    v_and_b32 v26, 3, v0
    v_max_u32 v26, 1, v26
    v_xor_b32 v26, s25, v26
    v_lshlrev_b32 v26, 2, v26
    v_add_u32 v26, s23, v26
    v_lshlrev_b32 v26, 10, v26
    v_add_u32 v18, 1049216, v26
    s_barrier
    s_lshl_b32 s79, s70, 19
    s_add_u32 s79, s79, s73
    s_add_u32 s70, s70, 1
    s_cmp_eq_u32 s70, 7
    s_cselect_b32 s70, 0, s70
    s_add_u32 m0, s71, 114688
    s_add_u32 s61, s79, 0
    buffer_load_dwordx4 v10, s[40:43], s61 offen  lds
    s_waitcnt vmcnt(7)
    s_add_u32 m0, s71, 115712
    s_add_u32 s61, s79, 32768
    buffer_load_dwordx4 v10, s[40:43], s61 offen  lds
    s_waitcnt vmcnt(7)
    s_add_u32 m0, s71, 116736
    s_add_u32 s61, s79, 65536
    buffer_load_dwordx4 v5, s[40:43], s61 offen  lds
    s_waitcnt vmcnt(7)
    s_add_u32 m0, s71, 117760
    s_add_u32 s61, s79, 98304
    buffer_load_dwordx4 v5, s[40:43], s61 offen  lds
    s_add_u32 m0, s0, -8
    s_nop 0
    global_load_lds_dword v19, s[16:17] offset:8
    s_waitcnt vmcnt(8)
    s_bitcmp1_b32 s21, 0
    s_cbranch_scc1 Lodd
    s_add_u32 m0, s24, 32768
    s_lshl_b32 s61, s70, 7
    buffer_load_dwordx4 v8, s[36:39], s61 offen  lds
    s_waitcnt vmcnt(7)
    s_add_u32 m0, s24, 33792
    s_lshl_b32 s61, s70, 7
    buffer_load_dwordx4 v9, s[36:39], s61 offen  lds
    s_waitcnt vmcnt(7)
    s_lshl_b32 s79, s70, 19
    s_add_u32 s79, s79, s73
    s_add_u32 s70, s70, 1
    s_cmp_eq_u32 s70, 7
    s_cselect_b32 s70, 0, s70
    s_add_u32 m0, s71, 40960
    s_add_u32 s61, s79, 0
    buffer_load_dwordx4 v10, s[40:43], s61 offen  lds
    s_waitcnt vmcnt(7)
    s_add_u32 m0, s71, 41984
    s_add_u32 s61, s79, 32768
    buffer_load_dwordx4 v10, s[40:43], s61 offen  lds
    s_waitcnt vmcnt(7)
    s_add_u32 m0, s71, 43008
    s_add_u32 s61, s79, 65536
    buffer_load_dwordx4 v5, s[40:43], s61 offen  lds
    s_waitcnt vmcnt(7)
    s_add_u32 m0, s71, 44032
    s_add_u32 s61, s79, 98304
    buffer_load_dwordx4 v5, s[40:43], s61 offen  lds
    s_add_u32 m0, s0, -12
    s_nop 0
    global_load_lds_dword v19, s[16:17] offset:12
    s_waitcnt vmcnt(8)
    s_add_u32 m0, s24, 57344
    s_lshl_b32 s61, s70, 7
    buffer_load_dwordx4 v8, s[36:39], s61 offen  lds
    s_waitcnt vmcnt(7)
    s_add_u32 m0, s24, 58368
    s_lshl_b32 s61, s70, 7
    buffer_load_dwordx4 v9, s[36:39], s61 offen  lds
    s_waitcnt vmcnt(7)
    s_lshl_b32 s79, s70, 19
    s_add_u32 s79, s79, s73
    s_add_u32 s70, s70, 1
    s_cmp_eq_u32 s70, 7
    s_cselect_b32 s70, 0, s70
    s_add_u32 m0, s71, 65536
    s_add_u32 s61, s79, 0
    buffer_load_dwordx4 v10, s[40:43], s61 offen  lds
    s_waitcnt vmcnt(7)
    s_add_u32 m0, s71, 66560
    s_add_u32 s61, s79, 32768
    buffer_load_dwordx4 v10, s[40:43], s61 offen  lds
    s_waitcnt vmcnt(7)
    s_add_u32 m0, s71, 67584
    s_add_u32 s61, s79, 65536
    buffer_load_dwordx4 v5, s[40:43], s61 offen  lds
    s_waitcnt vmcnt(7)
    s_add_u32 m0, s71, 68608
    s_add_u32 s61, s79, 98304
    buffer_load_dwordx4 v5, s[40:43], s61 offen  lds
    s_add_u32 m0, s0, -16
    s_nop 0
    global_load_lds_dword v19, s[16:17] offset:16
    s_waitcnt vmcnt(8)
    s_add_u32 m0, s24, 131072
    s_lshl_b32 s61, s70, 7
    buffer_load_dwordx4 v8, s[36:39], s61 offen  lds
    s_waitcnt vmcnt(7)
    s_add_u32 m0, s24, 132096
    s_lshl_b32 s61, s70, 7
    buffer_load_dwordx4 v9, s[36:39], s61 offen  lds
    s_waitcnt vmcnt(7)
    s_lshl_b32 s79, s70, 19
    s_add_u32 s79, s79, s73
    s_add_u32 s70, s70, 1
    s_cmp_eq_u32 s70, 7
    s_cselect_b32 s70, 0, s70
    s_add_u32 m0, s71, 139264
    s_add_u32 s61, s79, 0
    buffer_load_dwordx4 v10, s[40:43], s61 offen  lds
    s_waitcnt vmcnt(7)
    s_add_u32 m0, s71, 140288
    s_add_u32 s61, s79, 32768
    buffer_load_dwordx4 v10, s[40:43], s61 offen  lds
    s_waitcnt vmcnt(7)
    s_add_u32 m0, s71, 141312
    s_add_u32 s61, s79, 65536
    buffer_load_dwordx4 v5, s[40:43], s61 offen  lds
    s_waitcnt vmcnt(7)
    s_add_u32 m0, s71, 142336
    s_add_u32 s61, s79, 98304
    buffer_load_dwordx4 v5, s[40:43], s61 offen  lds
    s_add_u32 m0, s0, -20
    s_nop 0
    global_load_lds_dword v19, s[16:17] offset:20
    s_waitcnt vmcnt(8)
    s_waitcnt lgkmcnt(0)
    s_add_u32 s26, s26, 0x6b43a9b5
    s_add_u32 s27, s27, 0x3c6ef300
    s_and_b32 s27, s27, 0xffffff00
    s_getreg_b32 s60, hwreg(HW_REG_XCC_ID, 0, 4)
    s_lshl_b32 s60, s60, 4
    s_or_b32 s29, s27, s60
    v_cmp_gt_u32 vcc, 1, v4
    s_cbranch_vccnz Ls_168
Lb_169:
    s_add_u32 m0, s24, 81920
    s_lshl_b32 s61, s70, 7
    buffer_load_dwordx4 v8, s[36:39], s61 offen  lds
    s_waitcnt vmcnt(7)
    s_add_u32 m0, s24, 82944
    s_lshl_b32 s61, s70, 7
    buffer_load_dwordx4 v9, s[36:39], s61 offen  lds
    s_waitcnt vmcnt(7)
    s_lshl_b32 s79, s70, 19
    s_add_u32 s79, s79, s73
    s_add_u32 s70, s70, 1
    s_cmp_eq_u32 s70, 7
    s_cselect_b32 s70, 0, s70
    s_add_u32 m0, s71, 90112
    s_add_u32 s61, s79, 0
    buffer_load_dwordx4 v10, s[40:43], s61 offen  lds
    s_waitcnt vmcnt(7)
    s_add_u32 m0, s71, 91136
    s_add_u32 s61, s79, 32768
    buffer_load_dwordx4 v10, s[40:43], s61 offen  lds
    s_waitcnt vmcnt(7)
    s_add_u32 m0, s71, 92160
    s_add_u32 s61, s79, 65536
    buffer_load_dwordx4 v5, s[40:43], s61 offen  lds
    s_waitcnt vmcnt(7)
    s_add_u32 m0, s71, 93184
    s_add_u32 s61, s79, 98304
    buffer_load_dwordx4 v5, s[40:43], s61 offen  lds
    s_add_u32 m0, s0, -24
    s_nop 0
    global_load_lds_dword v19, s[16:17] offset:24
    s_waitcnt vmcnt(8)
    v_cmp_gt_u32 vcc, 2, v4
    s_cbranch_vccnz Ls_170
Lb_171:
    s_add_u32 m0, s24, 106496
    s_lshl_b32 s61, s70, 7
    buffer_load_dwordx4 v8, s[36:39], s61 offen  lds
    s_waitcnt vmcnt(7)
    s_add_u32 m0, s24, 107520
    s_lshl_b32 s61, s70, 7
    buffer_load_dwordx4 v9, s[36:39], s61 offen  lds
    s_waitcnt vmcnt(7)
    s_lshl_b32 s79, s70, 19
    s_add_u32 s79, s79, s73
    s_add_u32 s70, s70, 1
    s_cmp_eq_u32 s70, 7
    s_cselect_b32 s70, 0, s70
    s_add_u32 m0, s71, 114688
    s_add_u32 s61, s79, 0
    buffer_load_dwordx4 v10, s[40:43], s61 offen  lds
    s_waitcnt vmcnt(7)
    s_add_u32 m0, s71, 115712
    s_add_u32 s61, s79, 32768
    buffer_load_dwordx4 v10, s[40:43], s61 offen  lds
    s_waitcnt vmcnt(7)
    s_add_u32 m0, s71, 116736
    s_add_u32 s61, s79, 65536
    buffer_load_dwordx4 v5, s[40:43], s61 offen  lds
    s_waitcnt vmcnt(7)
    s_add_u32 m0, s71, 117760
    s_add_u32 s61, s79, 98304
    buffer_load_dwordx4 v5, s[40:43], s61 offen  lds
    s_add_u32 m0, s0, -28
    s_nop 0
    global_load_lds_dword v19, s[16:17] offset:28
    s_waitcnt vmcnt(8)
    s_mul_i32 s70, s23, 6144
    s_add_u32 s70, s70, 131072
    v_cmp_gt_u32 vcc, 6, v6
    s_cbranch_vccnz Ls_172
Lb_173:
    s_xor_b32 s61, s22, 0
    s_mul_i32 s61, s61, 57344
    s_add_u32 s61, s61, s72
    buffer_load_dword v15, v30, s[52:55], s61 offen
    s_xor_b32 s61, s22, 0
    s_mul_i32 s61, s61, 57344
    s_add_u32 s61, s61, s72
    s_bitcmp1_b32 s21, 0
    s_cselect_b32 s60, -1, 1
    s_mul_i32 s60, s60, 7168
    s_add_u32 s61, s61, s60
    buffer_load_dword v15, v30, s[52:55], s61 offen
    s_waitcnt vmcnt(8)
    s_add_u32 m0, s24, 16384
    s_add_u32 s61, s62, 0
    buffer_load_dwordx4 v11, s[44:47], s61 offen nt lds
    s_waitcnt vmcnt(6)
    s_add_u32 m0, s24, 17408
    s_add_u32 s61, s62, 0
    buffer_load_dwordx4 v12, s[44:47], s61 offen nt lds
    s_waitcnt vmcnt(6)
    s_add_u32 m0, s24, 24576
    s_add_u32 s61, s62, 262144
    buffer_load_dwordx4 v11, s[44:47], s61 offen nt lds
    s_waitcnt vmcnt(6)
    s_add_u32 m0, s24, 25600
    s_add_u32 s61, s62, 262144
    buffer_load_dwordx4 v12, s[44:47], s61 offen nt lds
    s_add_u32 m0, s0, 1020
    s_nop 0
    global_load_lds_dword v19, s[16:17] offset:4
    s_waitcnt vmcnt(6)
    v_cmp_gt_u32 vcc, 5, v4
    s_cbranch_vccnz Ls_174
Lb_175:
    s_add_u32 m0, s24, 32768
    s_add_u32 s61, s63, 0
    buffer_load_dwordx4 v11, s[44:47], s61 offen nt lds
    s_waitcnt vmcnt(6)
    s_add_u32 m0, s24, 33792
    s_add_u32 s61, s63, 0
    buffer_load_dwordx4 v12, s[44:47], s61 offen nt lds
    s_waitcnt vmcnt(6)
    s_add_u32 m0, s24, 40960
    s_add_u32 s61, s63, 262144
    buffer_load_dwordx4 v11, s[44:47], s61 offen nt lds
    s_waitcnt vmcnt(6)
    s_add_u32 m0, s24, 41984
    s_add_u32 s61, s63, 262144
    buffer_load_dwordx4 v12, s[44:47], s61 offen nt lds
    s_add_u32 m0, s0, 1016
    s_nop 0
    global_load_lds_dword v19, s[16:17] offset:8
    s_waitcnt vmcnt(7)
    v_cmp_gt_u32 vcc, 5, v4
    s_cbranch_vccnz Ls_176
Lb_177:
    s_xor_b32 s73, s22, 0
    s_mul_i32 s73, s73, 57344
    s_add_u32 s73, s73, s78
    s_add_u32 m0, s70, 0
    s_add_u32 s61, s73, 0
    buffer_load_dwordx4 v14, s[52:55], s61 offen  lds
    s_waitcnt vmcnt(7)
    s_add_u32 m0, s24, 49152
    s_add_u32 s61, s64, 0
    buffer_load_dwordx4 v11, s[44:47], s61 offen nt lds
    s_waitcnt vmcnt(6)
    s_add_u32 m0, s24, 50176
    s_add_u32 s61, s64, 0
    buffer_load_dwordx4 v12, s[44:47], s61 offen nt lds
    s_waitcnt vmcnt(6)
    s_add_u32 m0, s24, 57344
    s_add_u32 s61, s64, 262144
    buffer_load_dwordx4 v11, s[44:47], s61 offen nt lds
    s_waitcnt vmcnt(6)
    s_add_u32 m0, s70, 1024
    s_add_u32 s61, s73, 7168
    buffer_load_dwordx4 v14, s[52:55], s61 offen  lds
    s_waitcnt vmcnt(6)
    s_add_u32 m0, s24, 58368
    s_add_u32 s61, s64, 262144
    buffer_load_dwordx4 v12, s[44:47], s61 offen nt lds
    s_add_u32 m0, s0, 1012
    s_nop 0
    global_load_lds_dword v19, s[16:17] offset:12
    s_waitcnt vmcnt(6)
    ds_read_b64_tr_b16 v[128:129], v16 offset:0
    ds_read_b64_tr_b16 v[130:131], v16 offset:512
    s_add_u32 m0, s24, 65536
    s_add_u32 s61, s65, 0
    buffer_load_dwordx4 v11, s[44:47], s61 offen nt lds
    s_waitcnt vmcnt(6)
    s_add_u32 m0, s24, 66560
    s_add_u32 s61, s65, 0
    buffer_load_dwordx4 v12, s[44:47], s61 offen nt lds
    s_waitcnt vmcnt(6)
    s_add_u32 m0, s70, 2048
    s_add_u32 s61, s73, 28672
    buffer_load_dwordx4 v14, s[52:55], s61 offen  lds
    s_waitcnt vmcnt(6)
    s_add_u32 m0, s24, 73728
    s_add_u32 s61, s65, 262144
    buffer_load_dwordx4 v11, s[44:47], s61 offen nt lds
    s_waitcnt vmcnt(6)
    ds_read_b64_tr_b16 v[132:133], v16 offset:1024
    ds_read_b64_tr_b16 v[134:135], v16 offset:1536
    s_add_u32 m0, s24, 74752
    s_add_u32 s61, s65, 262144
    buffer_load_dwordx4 v12, s[44:47], s61 offen nt lds
    s_add_u32 m0, s0, 1008
    s_nop 0
    global_load_lds_dword v19, s[16:17] offset:16
    s_waitcnt vmcnt(7)
    s_xor_b32 s79, s22, 1
    s_lshl_b32 s79, s79, 7
    s_add_u32 s3, s74, s79
    s_add_u32 m0, s24, 0
    s_add_u32 s61, s3, 0
    buffer_load_dwordx4 v13, s[48:51], s61 offen nt lds
    s_waitcnt vmcnt(6)
    s_add_u32 m0, s70, 3072
    s_add_u32 s61, s73, 35840
    buffer_load_dwordx4 v14, s[52:55], s61 offen  lds
    s_waitcnt vmcnt(6)
    s_add_u32 m0, s24, 1024
    s_add_u32 s61, s3, 131072
    buffer_load_dwordx4 v13, s[48:51], s61 offen nt lds
    s_add_u32 m0, s0, 2044
    s_nop 0
    global_load_lds_dword v19, s[16:17] offset:4
    s_waitcnt vmcnt(7)
    ds_read_b64_tr_b16 v[136:137], v16 offset:2048
    ds_read_b64_tr_b16 v[138:139], v16 offset:2560
    v_cmp_gt_u32 vcc, 7, v4
    s_cbranch_vccnz Ls_178
Lb_179:
    s_add_u32 m0, s24, 81920
    s_add_u32 s61, s66, 0
    buffer_load_dwordx4 v11, s[44:47], s61 offen nt lds
    s_waitcnt vmcnt(7)
    s_add_u32 m0, s24, 82944
    s_add_u32 s61, s66, 0
    buffer_load_dwordx4 v12, s[44:47], s61 offen nt lds
    s_waitcnt vmcnt(7)
    s_add_u32 m0, s70, 4096
    s_add_u32 s61, s73, 229376
    buffer_load_dwordx4 v14, s[52:55], s61 offen  lds
    s_waitcnt vmcnt(6)
    s_add_u32 m0, s24, 90112
    s_add_u32 s61, s66, 262144
    buffer_load_dwordx4 v11, s[44:47], s61 offen nt lds
    s_waitcnt vmcnt(6)
    ds_read_b64_tr_b16 v[140:141], v16 offset:3072
    ds_read_b64_tr_b16 v[142:143], v16 offset:3584
    s_add_u32 m0, s24, 91136
    s_add_u32 s61, s66, 262144
    buffer_load_dwordx4 v12, s[44:47], s61 offen nt lds
    s_add_u32 m0, s0, 1004
    s_nop 0
    global_load_lds_dword v19, s[16:17] offset:20
    s_waitcnt vmcnt(7)
    s_add_u32 m0, s24, 98304
    s_add_u32 s61, s67, 0
    buffer_load_dwordx4 v11, s[44:47], s61 offen nt lds
    s_waitcnt vmcnt(6)
    s_add_u32 m0, s70, 5120
    s_add_u32 s61, s73, 236544
    buffer_load_dwordx4 v14, s[52:55], s61 offen  lds
    s_waitcnt vmcnt(6)
    s_add_u32 m0, s24, 99328
    s_add_u32 s61, s67, 0
    buffer_load_dwordx4 v12, s[44:47], s61 offen nt lds
    s_waitcnt vmcnt(6)
    ds_read_b64_tr_b16 v[144:145], v16 offset:4096
    ds_read_b64_tr_b16 v[146:147], v16 offset:4608
    s_add_u32 m0, s24, 106496
    s_add_u32 s61, s67, 262144
    buffer_load_dwordx4 v11, s[44:47], s61 offen nt lds
    s_waitcnt vmcnt(6)
    s_add_u32 m0, s24, 107520
    s_add_u32 s61, s67, 262144
    buffer_load_dwordx4 v12, s[44:47], s61 offen nt lds
    s_add_u32 m0, s0, 1000
    s_nop 0
    global_load_lds_dword v19, s[16:17] offset:24
    s_waitcnt vmcnt(7)
    s_waitcnt lgkmcnt(8)
    s_add_u32 m0, s70, 0
    s_add_u32 s61, s73, 258048
    buffer_load_dwordx4 v14, s[52:55], s61 offen  lds
    s_waitcnt vmcnt(6)
    s_add_u32 m0, s24, 114688
    s_add_u32 s61, s68, 0
    buffer_load_dwordx4 v11, s[44:47], s61 offen nt lds
    s_waitcnt vmcnt(6)
    ds_read_b64_tr_b16 v[148:149], v16 offset:5120
    ds_read_b64_tr_b16 v[150:151], v16 offset:5632
    s_add_u32 m0, s24, 115712
    s_add_u32 s61, s68, 0
    buffer_load_dwordx4 v12, s[44:47], s61 offen nt lds
    s_waitcnt vmcnt(6)
    s_add_u32 m0, s24, 122880
    s_add_u32 s61, s68, 262144
    buffer_load_dwordx4 v11, s[44:47], s61 offen nt lds
    s_waitcnt vmcnt(6)
    s_waitcnt lgkmcnt(8)
    s_add_u32 m0, s70, 1024
    s_add_u32 s61, s73, 265216
    buffer_load_dwordx4 v14, s[52:55], s61 offen  lds
    s_waitcnt vmcnt(6)
    s_add_u32 m0, s24, 123904
    s_add_u32 s61, s68, 262144
    buffer_load_dwordx4 v12, s[44:47], s61 offen nt lds
    s_add_u32 m0, s0, 996
    s_nop 0
    global_load_lds_dword v19, s[16:17] offset:28
    s_waitcnt vmcnt(5)
    ds_read_b64_tr_b16 v[152:153], v16 offset:0
    ds_read_b64_tr_b16 v[154:155], v16 offset:512
    v_cmp_gt_u32 vcc, 9, v4
    s_cbranch_vccnz Ls_180
Lb_181:
    buffer_load_dwordx2 v[24:25], v18, s[32:35], 0 offen sc1
    s_add_u32 m0, s24, 16384
    s_add_u32 s61, s69, 0
    buffer_load_dwordx4 v11, s[44:47], s61 offen nt lds
    s_waitcnt vmcnt(6)
    s_add_u32 m0, s24, 17408
    s_add_u32 s61, s69, 0
    buffer_load_dwordx4 v12, s[44:47], s61 offen nt lds
    s_waitcnt vmcnt(6)
    s_add_u32 m0, s24, 24576
    s_add_u32 s61, s69, 262144
    buffer_load_dwordx4 v11, s[44:47], s61 offen nt lds
    s_waitcnt vmcnt(6)
    ds_read_b64_tr_b16 v[156:157], v16 offset:1024
    ds_read_b64_tr_b16 v[158:159], v16 offset:1536
    s_add_u32 m0, s24, 25600
    s_add_u32 s61, s69, 262144
    buffer_load_dwordx4 v12, s[44:47], s61 offen nt lds
    s_add_u32 m0, s0, 992
    s_nop 0
    global_load_lds_dword v19, s[16:17] offset:32
    s_waitcnt vmcnt(7)
    s_xor_b32 s79, s22, 1
    s_lshl_b32 s79, s79, 7
    s_add_u32 s3, s75, s79
    s_add_u32 m0, s24, 8192
    s_add_u32 s61, s3, 0
    buffer_load_dwordx4 v13, s[48:51], s61 offen nt lds
    s_waitcnt vmcnt(5)
    s_add_u32 m0, s24, 9216
    s_add_u32 s61, s3, 131072
    buffer_load_dwordx4 v13, s[48:51], s61 offen nt lds
    s_add_u32 m0, s0, 2040
    s_nop 0
    global_load_lds_dword v19, s[16:17] offset:8
    s_waitcnt vmcnt(6)
    s_xor_b32 s79, s22, 1
    s_lshl_b32 s79, s79, 7
    s_add_u32 s3, s76, s79
    s_add_u32 m0, s24, 32768
    s_add_u32 s61, s3, 0
    buffer_load_dwordx4 v13, s[48:51], s61 offen nt lds
    s_waitcnt vmcnt(6)
    s_add_u32 m0, s24, 33792
    s_add_u32 s61, s3, 131072
    buffer_load_dwordx4 v13, s[48:51], s61 offen nt lds
    s_add_u32 m0, s0, 2036
    s_nop 0
    global_load_lds_dword v19, s[16:17] offset:12
    s_waitcnt vmcnt(7)
Lc_182:
    v_xor_b32 v25, s29, v25
    v_and_b32 v3, 0xf0, v25
    v_cmp_ne_u32 vcc, 0, v3
    s_cmp_lg_u64 vcc, 0
    s_cselect_b32 s30, 1, 0
    v_and_b32 v25, 0xffffff0f, v25
    v_subrev_u32 v25, 3, v25
    v_cmp_lt_u32 s[60:61], 12, v25
    v_cmp_ne_u32 vcc, s26, v24
    s_or_b64 vcc, vcc, s[60:61]
    s_cbranch_vccnz Ls_183
Lb_184:
    s_add_u32 s3, s77, s79
    s_add_u32 m0, s24, 40960
    s_add_u32 s61, s3, 0
    buffer_load_dwordx4 v13, s[48:51], s61 offen nt lds
    s_waitcnt vmcnt(6)
    s_add_u32 m0, s24, 41984
    s_add_u32 s61, s3, 131072
    buffer_load_dwordx4 v13, s[48:51], s61 offen nt lds
    s_add_u32 m0, s0, 2032
    s_nop 0
    global_load_lds_dword v19, s[16:17] offset:16
    s_waitcnt vmcnt(7)
    v_cmp_gt_u32 vcc, 11, v4
    s_cbranch_vccnz Ls_187
Lb_188:
    s_xor_b32 s79, s22, 2
    s_lshl_b32 s79, s79, 7
    s_add_u32 s3, s74, s79
    s_add_u32 m0, s24, 49152
    s_add_u32 s61, s3, 0
    buffer_load_dwordx4 v13, s[48:51], s61 offen nt lds
    s_waitcnt vmcnt(6)
    s_add_u32 m0, s24, 50176
    s_add_u32 s61, s3, 131072
    buffer_load_dwordx4 v13, s[48:51], s61 offen nt lds
    s_add_u32 m0, s0, 2028
    s_nop 0
    global_load_lds_dword v19, s[16:17] offset:20
    s_waitcnt vmcnt(7)
    s_add_u32 s3, s75, s79
    s_add_u32 m0, s24, 57344
    s_add_u32 s61, s3, 0
    buffer_load_dwordx4 v13, s[48:51], s61 offen nt lds
    s_waitcnt vmcnt(6)
    s_add_u32 m0, s24, 58368
    s_add_u32 s61, s3, 131072
    buffer_load_dwordx4 v13, s[48:51], s61 offen nt lds
    s_add_u32 m0, s0, 2024
    s_nop 0
    global_load_lds_dword v19, s[16:17] offset:24
    s_waitcnt vmcnt(7)
    s_mov_b32 s56, s14
    s_and_b32 s57, s15, 0xffff
    s_mov_b32 s58, 458752
    s_mov_b32 s59, 0x00020000
    s_lshl_b32 s62, s22, 2
    s_add_u32 s62, s62, s23
    s_sub_u32 s62, s62, 11
    s_mul_i32 s12, s25, 18432
    s_mul_i32 s63, s23, 4608
    s_add_u32 s63, s63, 6291456
    s_add_u32 s12, s12, s63
    s_add_u32 s13, s12, 4096
    s_and_b32 s64, s25, 31
    s_mul_i32 s64, s64, 18432
    s_add_u32 s64, s64, s63
    s_lshl_b32 s63, s20, 6
    s_add_u32 s14, s64, s63
    s_lshl_b32 s63, s20, 9
    s_add_u32 s64, s64, s63
    s_add_u32 s4, s64, 0
    s_add_u32 s8, s14, 4096
    s_add_u32 s5, s64, 1179648
    s_add_u32 s9, s14, 1183744
    s_add_u32 s6, s64, 2359296
    s_add_u32 s10, s14, 2363392
    s_add_u32 s7, s64, 3538944
    s_add_u32 s11, s14, 3543040
    s_add_u32 s15, s26, 5
    s_lshl_b32 s64, s15, 2
    s_lshl_b32 s65, s21, 3
    s_add_u32 s65, s65, s20
    s_mul_i32 s65, s65, 7168
    s_add_u32 s65, s65, s31
    s_lshl_b32 s14, s23, 6
    s_add_u32 s65, s65, s14
    v_mov_b32 v8, s26
    v_mov_b32 v9, s27
    v_and_b32 v26, 15, v0
    v_lshlrev_b32 v26, 4, v26
    v_lshl_add_u32 v26, v23, 8, v26
    v_bfe_u32 v27, v0, 4, 1
    v_lshl_add_u32 v26, v27, 10, v26
    v_add_u32 v17, 32768, v26
    v_bfe_u32 v26, v0, 3, 2
    v_lshlrev_b32 v20, 9, v26
    v_lshl_add_u32 v20, v23, 7, v20
    v_lshl_add_u32 v20, v21, 4, v20
    v_lshlrev_b32 v27, 6, v26
    v_lshl_add_u32 v27, v23, 5, v27
    v_lshl_add_u32 v27, v21, 2, v27
    v_mul_u32_u24 v28, 589824, v23
    v_and_b32 v24, 15, v0
    v_lshl_add_u32 v29, v24, 2, v28
    v_and_b32 v24, 31, v0
    v_lshl_add_u32 v28, v24, 4, v28
    v_mul_u32_u24 v24, 896, v21
    v_lshl_add_u32 v23, v23, 3, v24
    v_bfe_u32 v26, v0, 3, 1
    v_lshl_add_u32 v23, v26, 5, v23
    v_bfe_u32 v26, v0, 4, 1
    v_lshl_add_u32 v23, v26, 4, v23
    s_add_u32 s3, s76, s79
    s_add_u32 m0, s24, 65536
    s_add_u32 s61, s3, 0
    buffer_load_dwordx4 v13, s[48:51], s61 offen nt lds
    s_waitcnt vmcnt(6)
    s_add_u32 m0, s24, 66560
    s_add_u32 s61, s3, 131072
    buffer_load_dwordx4 v13, s[48:51], s61 offen nt lds
    s_add_u32 m0, s0, 2020
    s_nop 0
    global_load_lds_dword v19, s[16:17] offset:28
    s_waitcnt vmcnt(7)
    s_add_u32 s3, s77, s79
    s_add_u32 m0, s24, 73728
    s_add_u32 s61, s3, 0
    buffer_load_dwordx4 v13, s[48:51], s61 offen nt lds
    s_waitcnt vmcnt(6)
    s_add_u32 m0, s24, 74752
    s_add_u32 s61, s3, 131072
    buffer_load_dwordx4 v13, s[48:51], s61 offen nt lds
    s_add_u32 m0, s0, 2016
    s_nop 0
    global_load_lds_dword v19, s[16:17] offset:32
    s_waitcnt vmcnt(7)
    v_cmp_gt_u32 vcc, 15, v4
    s_cbranch_vccnz Ls_189
Lb_190:
    s_xor_b32 s79, s22, 3
    s_lshl_b32 s79, s79, 7
    s_add_u32 s3, s74, s79
    s_add_u32 m0, s24, 81920
    s_add_u32 s61, s3, 0
    buffer_load_dwordx4 v13, s[48:51], s61 offen nt lds
    s_waitcnt vmcnt(6)
    s_add_u32 m0, s24, 82944
    s_add_u32 s61, s3, 131072
    buffer_load_dwordx4 v13, s[48:51], s61 offen nt lds
    s_add_u32 m0, s0, 2012
    s_nop 0
    global_load_lds_dword v19, s[16:17] offset:36
    s_waitcnt vmcnt(7)
    s_add_u32 s3, s75, s79
    s_add_u32 m0, s24, 90112
    s_add_u32 s61, s3, 0
    buffer_load_dwordx4 v13, s[48:51], s61 offen nt lds
    s_waitcnt vmcnt(6)
    s_add_u32 m0, s24, 91136
    s_add_u32 s61, s3, 131072
    buffer_load_dwordx4 v13, s[48:51], s61 offen nt lds
    s_add_u32 m0, s0, 2008
    s_nop 0
    global_load_lds_dword v19, s[16:17] offset:40
    s_waitcnt vmcnt(7)
    s_add_u32 s3, s76, s79
    s_add_u32 m0, s24, 98304
    s_add_u32 s61, s3, 0
    buffer_load_dwordx4 v13, s[48:51], s61 offen nt lds
    s_waitcnt vmcnt(6)
    s_add_u32 m0, s24, 99328
    s_add_u32 s61, s3, 131072
    buffer_load_dwordx4 v13, s[48:51], s61 offen nt lds
    s_add_u32 m0, s0, 2004
    s_nop 0
    global_load_lds_dword v19, s[16:17] offset:44
    s_waitcnt vmcnt(7)
    s_add_u32 s3, s77, s79
    s_add_u32 m0, s24, 106496
    s_add_u32 s61, s3, 0
    buffer_load_dwordx4 v13, s[48:51], s61 offen nt lds
    s_waitcnt vmcnt(6)
    s_add_u32 m0, s24, 107520
    s_add_u32 s61, s3, 131072
    buffer_load_dwordx4 v13, s[48:51], s61 offen nt lds
    s_add_u32 m0, s0, 2000
    s_nop 0
    global_load_lds_dword v19, s[16:17] offset:48
    s_waitcnt vmcnt(7)
    s_xor_b32 s79, s22, 0
    s_lshl_b32 s79, s79, 7
    s_add_u32 s3, s74, s79
    s_add_u32 m0, s24, 114688
    s_add_u32 s61, s3, 0
    buffer_load_dwordx4 v13, s[48:51], s61 offen nt lds
    s_waitcnt vmcnt(6)
    s_add_u32 m0, s24, 115712
    s_add_u32 s61, s3, 131072
    buffer_load_dwordx4 v13, s[48:51], s61 offen nt lds
    s_add_u32 m0, s0, 1996
    s_nop 0
    global_load_lds_dword v19, s[16:17] offset:52
    s_waitcnt vmcnt(7)
    s_add_u32 s3, s75, s79
    s_add_u32 m0, s24, 122880
    s_add_u32 s61, s3, 0
    buffer_load_dwordx4 v13, s[48:51], s61 offen nt lds
    s_waitcnt vmcnt(6)
    s_add_u32 m0, s24, 123904
    s_add_u32 s61, s3, 131072
    buffer_load_dwordx4 v13, s[48:51], s61 offen nt lds
    s_add_u32 m0, s0, 1992
    s_nop 0
    global_load_lds_dword v19, s[16:17] offset:56
    s_waitcnt vmcnt(7)
    s_add_u32 s3, s76, s79
    s_add_u32 m0, s24, 16384
    s_add_u32 s61, s3, 0
    buffer_load_dwordx4 v13, s[48:51], s61 offen nt lds
    s_waitcnt vmcnt(6)
    s_add_u32 m0, s24, 17408
    s_add_u32 s61, s3, 131072
    buffer_load_dwordx4 v13, s[48:51], s61 offen nt lds
    s_add_u32 m0, s0, 1988
    s_nop 0
    global_load_lds_dword v19, s[16:17] offset:60
    s_waitcnt vmcnt(7)
    s_add_u32 s3, s77, s79
    s_add_u32 m0, s24, 24576
    s_add_u32 s61, s3, 0
    buffer_load_dwordx4 v13, s[48:51], s61 offen nt lds
    s_waitcnt vmcnt(6)
    s_add_u32 m0, s24, 25600
    s_add_u32 s61, s3, 131072
    buffer_load_dwordx4 v13, s[48:51], s61 offen nt lds
    s_add_u32 m0, s0, 1984
    s_nop 0
    global_load_lds_dword v19, s[16:17] offset:64
    s_waitcnt vmcnt(7)
    s_branch Ljoin
Lodd:
    s_xor_b32 s61, s25, 4
    s_lshl_b32 s61, s61, 14
    s_add_u32 s61, s61, s71
    s_add_u32 s61, s61, 2097152
    buffer_load_dword v15, v31, s[32:35], s61 offen
    s_xor_b32 s61, s25, 4
    s_lshl_b32 s61, s61, 14
    s_add_u32 s61, s61, s71
    s_add_u32 s61, s61, 2098176
    buffer_load_dword v15, v31, s[32:35], s61 offen
    s_waitcnt vmcnt(8)
    s_xor_b32 s61, s25, 4
    s_lshl_b32 s61, s61, 14
    s_add_u32 s61, s61, s71
    s_add_u32 s61, s61, 2099200
    buffer_load_dword v15, v31, s[32:35], s61 offen
    s_waitcnt vmcnt(8)
    s_xor_b32 s61, s25, 4
    s_lshl_b32 s61, s61, 14
    s_add_u32 s61, s61, s71
    s_add_u32 s61, s61, 2100224
    buffer_load_dword v15, v31, s[32:35], s61 offen
    s_waitcnt vmcnt(8)
    s_xor_b32 s61, s25, 0
    s_lshl_b32 s61, s61, 14
    s_add_u32 s61, s61, s71
    s_add_u32 s61, s61, 2097152
    buffer_load_dword v15, v31, s[32:35], s61 offen
    s_waitcnt vmcnt(8)
    s_xor_b32 s61, s25, 0
    s_lshl_b32 s61, s61, 14
    s_add_u32 s61, s61, s71
    s_add_u32 s61, s61, 2098176
    buffer_load_dword v15, v31, s[32:35], s61 offen
    s_waitcnt vmcnt(8)
    s_xor_b32 s61, s25, 0
    s_lshl_b32 s61, s61, 14
    s_add_u32 s61, s61, s71
    s_add_u32 s61, s61, 2099200
    buffer_load_dword v15, v31, s[32:35], s61 offen
    s_waitcnt vmcnt(8)
    s_xor_b32 s61, s25, 0
    s_lshl_b32 s61, s61, 14
    s_add_u32 s61, s61, s71
    s_add_u32 s61, s61, 2100224
    buffer_load_dword v15, v31, s[32:35], s61 offen
    s_waitcnt vmcnt(7)
    s_xor_b32 s79, s22, 1
    s_lshl_b32 s79, s79, 7
    s_add_u32 s3, s74, s79
    s_add_u32 m0, s24, 0
    s_add_u32 s61, s3, 0
    buffer_load_dwordx4 v13, s[48:51], s61 offen nt lds
    s_waitcnt vmcnt(7)
    s_add_u32 m0, s24, 1024
    s_add_u32 s61, s3, 131072
    buffer_load_dwordx4 v13, s[48:51], s61 offen nt lds
    s_add_u32 m0, s0, 2044
    s_nop 0
    global_load_lds_dword v19, s[16:17] offset:4
    s_waitcnt vmcnt(8)
    s_xor_b32 s79, s22, 1
    s_lshl_b32 s79, s79, 7
    s_add_u32 s3, s75, s79
    s_add_u32 m0, s24, 8192
    s_add_u32 s61, s3, 0
    buffer_load_dwordx4 v13, s[48:51], s61 offen nt lds
    s_waitcnt vmcnt(8)
    s_add_u32 m0, s24, 9216
    s_add_u32 s61, s3, 131072
    buffer_load_dwordx4 v13, s[48:51], s61 offen nt lds
    s_add_u32 m0, s0, 2040
    s_nop 0
    global_load_lds_dword v19, s[16:17] offset:8
    s_waitcnt vmcnt(9)
    s_add_u32 m0, s24, 16384
    s_add_u32 s61, s62, 0
    buffer_load_dwordx4 v11, s[44:47], s61 offen nt lds
    s_waitcnt vmcnt(9)
    s_add_u32 m0, s24, 17408
    s_add_u32 s61, s62, 0
    buffer_load_dwordx4 v12, s[44:47], s61 offen nt lds
    s_waitcnt vmcnt(9)
    s_add_u32 m0, s24, 24576
    s_add_u32 s61, s62, 262144
    buffer_load_dwordx4 v11, s[44:47], s61 offen nt lds
    s_waitcnt vmcnt(9)
    s_add_u32 m0, s24, 25600
    s_add_u32 s61, s62, 262144
    buffer_load_dwordx4 v12, s[44:47], s61 offen nt lds
    s_add_u32 m0, s0, 1020
    s_nop 0
    global_load_lds_dword v19, s[16:17] offset:4
    s_waitcnt vmcnt(10)
    s_add_u32 m0, s24, 32768
    s_lshl_b32 s61, s70, 7
    buffer_load_dwordx4 v8, s[36:39], s61 offen  lds
    s_waitcnt vmcnt(8)
    s_add_u32 m0, s24, 33792
    s_lshl_b32 s61, s70, 7
    buffer_load_dwordx4 v9, s[36:39], s61 offen  lds
    s_waitcnt vmcnt(8)
    s_lshl_b32 s79, s70, 19
    s_add_u32 s79, s79, s73
    s_add_u32 s70, s70, 1
    s_cmp_eq_u32 s70, 7
    s_cselect_b32 s70, 0, s70
    s_add_u32 m0, s71, 40960
    s_add_u32 s61, s79, 0
    buffer_load_dwordx4 v10, s[40:43], s61 offen  lds
    s_waitcnt vmcnt(7)
    s_add_u32 m0, s71, 41984
    s_add_u32 s61, s79, 32768
    buffer_load_dwordx4 v10, s[40:43], s61 offen  lds
    s_waitcnt vmcnt(7)
    s_add_u32 m0, s71, 43008
    s_add_u32 s61, s79, 65536
    buffer_load_dwordx4 v5, s[40:43], s61 offen  lds
    s_waitcnt vmcnt(7)
    s_add_u32 m0, s71, 44032
    s_add_u32 s61, s79, 98304
    buffer_load_dwordx4 v5, s[40:43], s61 offen  lds
    s_add_u32 m0, s0, -12
    s_nop 0
    global_load_lds_dword v19, s[16:17] offset:12
    s_waitcnt vmcnt(8)
    s_add_u32 m0, s24, 57344
    s_lshl_b32 s61, s70, 7
    buffer_load_dwordx4 v8, s[36:39], s61 offen  lds
    s_waitcnt vmcnt(7)
    s_add_u32 m0, s24, 58368
    s_lshl_b32 s61, s70, 7
    buffer_load_dwordx4 v9, s[36:39], s61 offen  lds
    s_waitcnt vmcnt(7)
    s_lshl_b32 s79, s70, 19
    s_add_u32 s79, s79, s73
    s_add_u32 s70, s70, 1
    s_cmp_eq_u32 s70, 7
    s_cselect_b32 s70, 0, s70
    s_add_u32 m0, s71, 65536
    s_add_u32 s61, s79, 0
    buffer_load_dwordx4 v10, s[40:43], s61 offen  lds
    s_waitcnt vmcnt(7)
    s_add_u32 m0, s71, 66560
    s_add_u32 s61, s79, 32768
    buffer_load_dwordx4 v10, s[40:43], s61 offen  lds
    s_waitcnt vmcnt(7)
    s_add_u32 m0, s71, 67584
    s_add_u32 s61, s79, 65536
    buffer_load_dwordx4 v5, s[40:43], s61 offen  lds
    s_waitcnt vmcnt(7)
    s_add_u32 m0, s71, 68608
    s_add_u32 s61, s79, 98304
    buffer_load_dwordx4 v5, s[40:43], s61 offen  lds
    s_add_u32 m0, s0, -16
    s_nop 0
    global_load_lds_dword v19, s[16:17] offset:16
    s_waitcnt vmcnt(8)
    s_add_u32 m0, s24, 131072
    s_lshl_b32 s61, s70, 7
    buffer_load_dwordx4 v8, s[36:39], s61 offen  lds
    s_waitcnt vmcnt(7)
    s_add_u32 m0, s24, 132096
    s_lshl_b32 s61, s70, 7
    buffer_load_dwordx4 v9, s[36:39], s61 offen  lds
    s_waitcnt vmcnt(7)
    s_lshl_b32 s79, s70, 19
    s_add_u32 s79, s79, s73
    s_add_u32 s70, s70, 1
    s_cmp_eq_u32 s70, 7
    s_cselect_b32 s70, 0, s70
    s_add_u32 m0, s71, 139264
    s_add_u32 s61, s79, 0
    buffer_load_dwordx4 v10, s[40:43], s61 offen  lds
    s_waitcnt vmcnt(7)
    s_add_u32 m0, s71, 140288
    s_add_u32 s61, s79, 32768
    buffer_load_dwordx4 v10, s[40:43], s61 offen  lds
    s_waitcnt vmcnt(7)
    s_add_u32 m0, s71, 141312
    s_add_u32 s61, s79, 65536
    buffer_load_dwordx4 v5, s[40:43], s61 offen  lds
    s_waitcnt vmcnt(7)
    s_add_u32 m0, s71, 142336
    s_add_u32 s61, s79, 98304
    buffer_load_dwordx4 v5, s[40:43], s61 offen  lds
    s_add_u32 m0, s0, -20
    s_nop 0
    global_load_lds_dword v19, s[16:17] offset:20
    s_waitcnt vmcnt(8)
    s_waitcnt lgkmcnt(0)
    s_add_u32 s26, s26, 0x6b43a9b5
    s_add_u32 s27, s27, 0x3c6ef300
    s_and_b32 s27, s27, 0xffffff00
    s_getreg_b32 s60, hwreg(HW_REG_XCC_ID, 0, 4)
    s_lshl_b32 s60, s60, 4
    s_or_b32 s29, s27, s60
    v_cmp_gt_u32 vcc, 1, v4
    s_cbranch_vccnz Ls_191
Lb_192:
    s_add_u32 m0, s24, 81920
    s_lshl_b32 s61, s70, 7
    buffer_load_dwordx4 v8, s[36:39], s61 offen  lds
    s_waitcnt vmcnt(7)
    s_add_u32 m0, s24, 82944
    s_lshl_b32 s61, s70, 7
    buffer_load_dwordx4 v9, s[36:39], s61 offen  lds
    s_waitcnt vmcnt(7)
    s_lshl_b32 s79, s70, 19
    s_add_u32 s79, s79, s73
    s_add_u32 s70, s70, 1
    s_cmp_eq_u32 s70, 7
    s_cselect_b32 s70, 0, s70
    s_add_u32 m0, s71, 90112
    s_add_u32 s61, s79, 0
    buffer_load_dwordx4 v10, s[40:43], s61 offen  lds
    s_waitcnt vmcnt(7)
    s_add_u32 m0, s71, 91136
    s_add_u32 s61, s79, 32768
    buffer_load_dwordx4 v10, s[40:43], s61 offen  lds
    s_waitcnt vmcnt(7)
    s_add_u32 m0, s71, 92160
    s_add_u32 s61, s79, 65536
    buffer_load_dwordx4 v5, s[40:43], s61 offen  lds
    s_waitcnt vmcnt(7)
    s_add_u32 m0, s71, 93184
    s_add_u32 s61, s79, 98304
    buffer_load_dwordx4 v5, s[40:43], s61 offen  lds
    s_add_u32 m0, s0, -24
    s_nop 0
    global_load_lds_dword v19, s[16:17] offset:24
    s_waitcnt vmcnt(8)
    v_cmp_gt_u32 vcc, 2, v4
    s_cbranch_vccnz Ls_193
Lb_194:
    s_add_u32 m0, s24, 106496
    s_lshl_b32 s61, s70, 7
    buffer_load_dwordx4 v8, s[36:39], s61 offen  lds
    s_waitcnt vmcnt(7)
    s_add_u32 m0, s24, 107520
    s_lshl_b32 s61, s70, 7
    buffer_load_dwordx4 v9, s[36:39], s61 offen  lds
    s_waitcnt vmcnt(7)
    s_lshl_b32 s79, s70, 19
    s_add_u32 s79, s79, s73
    s_add_u32 s70, s70, 1
    s_cmp_eq_u32 s70, 7
    s_cselect_b32 s70, 0, s70
    s_add_u32 m0, s71, 114688
    s_add_u32 s61, s79, 0
    buffer_load_dwordx4 v10, s[40:43], s61 offen  lds
    s_waitcnt vmcnt(7)
    s_add_u32 m0, s71, 115712
    s_add_u32 s61, s79, 32768
    buffer_load_dwordx4 v10, s[40:43], s61 offen  lds
    s_waitcnt vmcnt(7)
    s_add_u32 m0, s71, 116736
    s_add_u32 s61, s79, 65536
    buffer_load_dwordx4 v5, s[40:43], s61 offen  lds
    s_waitcnt vmcnt(7)
    s_add_u32 m0, s71, 117760
    s_add_u32 s61, s79, 98304
    buffer_load_dwordx4 v5, s[40:43], s61 offen  lds
    s_add_u32 m0, s0, -28
    s_nop 0
    global_load_lds_dword v19, s[16:17] offset:28
    s_waitcnt vmcnt(8)
    s_mul_i32 s70, s23, 6144
    s_add_u32 s70, s70, 131072
    v_cmp_gt_u32 vcc, 6, v6
    s_cbranch_vccnz Ls_195
Lb_196:
    v_cmp_gt_u32 vcc, 5, v4
    s_cbranch_vccnz Ls_197
Lb_198:
    s_add_u32 m0, s24, 32768
    s_add_u32 s61, s63, 0
    buffer_load_dwordx4 v11, s[44:47], s61 offen nt lds
    s_waitcnt vmcnt(6)
    s_add_u32 m0, s24, 33792
    s_add_u32 s61, s63, 0
    buffer_load_dwordx4 v12, s[44:47], s61 offen nt lds
    s_waitcnt vmcnt(6)
    s_add_u32 m0, s24, 40960
    s_add_u32 s61, s63, 262144
    buffer_load_dwordx4 v11, s[44:47], s61 offen nt lds
    s_waitcnt vmcnt(6)
    s_add_u32 m0, s24, 41984
    s_add_u32 s61, s63, 262144
    buffer_load_dwordx4 v12, s[44:47], s61 offen nt lds
    s_add_u32 m0, s0, 1016
    s_nop 0
    global_load_lds_dword v19, s[16:17] offset:8
    s_waitcnt vmcnt(7)
    s_add_u32 m0, s24, 49152
    s_add_u32 s61, s64, 0
    buffer_load_dwordx4 v11, s[44:47], s61 offen nt lds
    s_waitcnt vmcnt(7)
    s_add_u32 m0, s24, 50176
    s_add_u32 s61, s64, 0
    buffer_load_dwordx4 v12, s[44:47], s61 offen nt lds
    s_waitcnt vmcnt(6)
    v_cmp_gt_u32 vcc, 5, v4
    s_cbranch_vccnz Ls_199
Lb_200:
    s_xor_b32 s73, s22, 0
    s_mul_i32 s73, s73, 57344
    s_add_u32 s73, s73, s78
    s_add_u32 m0, s70, 0
    s_add_u32 s61, s73, 0
    buffer_load_dwordx4 v14, s[52:55], s61 offen  lds
    s_waitcnt vmcnt(6)
    s_add_u32 m0, s24, 57344
    s_add_u32 s61, s64, 262144
    buffer_load_dwordx4 v11, s[44:47], s61 offen nt lds
    s_waitcnt vmcnt(6)
    s_add_u32 m0, s24, 58368
    s_add_u32 s61, s64, 262144
    buffer_load_dwordx4 v12, s[44:47], s61 offen nt lds
    s_add_u32 m0, s0, 1012
    s_nop 0
    global_load_lds_dword v19, s[16:17] offset:12
    s_waitcnt vmcnt(7)
    s_add_u32 m0, s24, 65536
    s_add_u32 s61, s65, 0
    buffer_load_dwordx4 v11, s[44:47], s61 offen nt lds
    s_waitcnt vmcnt(6)
    s_add_u32 m0, s70, 1024
    s_add_u32 s61, s73, 7168
    buffer_load_dwordx4 v14, s[52:55], s61 offen  lds
    s_waitcnt vmcnt(6)
    s_add_u32 m0, s24, 66560
    s_add_u32 s61, s65, 0
    buffer_load_dwordx4 v12, s[44:47], s61 offen nt lds
    s_waitcnt vmcnt(6)
    ds_read_b64_tr_b16 v[128:129], v16 offset:0
    ds_read_b64_tr_b16 v[130:131], v16 offset:512
    s_add_u32 m0, s24, 73728
    s_add_u32 s61, s65, 262144
    buffer_load_dwordx4 v11, s[44:47], s61 offen nt lds
    s_waitcnt vmcnt(6)
    s_add_u32 m0, s24, 74752
    s_add_u32 s61, s65, 262144
    buffer_load_dwordx4 v12, s[44:47], s61 offen nt lds
    s_add_u32 m0, s0, 1008
    s_nop 0
    global_load_lds_dword v19, s[16:17] offset:16
    s_waitcnt vmcnt(7)
    s_add_u32 m0, s70, 2048
    s_add_u32 s61, s73, 28672
    buffer_load_dwordx4 v14, s[52:55], s61 offen  lds
    s_waitcnt vmcnt(6)
    v_cmp_gt_u32 vcc, 7, v4
    s_cbranch_vccnz Ls_201
Lb_202:
    s_add_u32 m0, s24, 81920
    s_add_u32 s61, s66, 0
    buffer_load_dwordx4 v11, s[44:47], s61 offen nt lds
    s_waitcnt vmcnt(6)
    ds_read_b64_tr_b16 v[132:133], v16 offset:1024
    ds_read_b64_tr_b16 v[134:135], v16 offset:1536
    s_add_u32 m0, s24, 82944
    s_add_u32 s61, s66, 0
    buffer_load_dwordx4 v12, s[44:47], s61 offen nt lds
    s_waitcnt vmcnt(6)
    s_add_u32 m0, s24, 90112
    s_add_u32 s61, s66, 262144
    buffer_load_dwordx4 v11, s[44:47], s61 offen nt lds
    s_waitcnt vmcnt(6)
    s_add_u32 m0, s70, 3072
    s_add_u32 s61, s73, 35840
    buffer_load_dwordx4 v14, s[52:55], s61 offen  lds
    s_waitcnt vmcnt(6)
    s_add_u32 m0, s24, 91136
    s_add_u32 s61, s66, 262144
    buffer_load_dwordx4 v12, s[44:47], s61 offen nt lds
    s_add_u32 m0, s0, 1004
    s_nop 0
    global_load_lds_dword v19, s[16:17] offset:20
    s_waitcnt vmcnt(6)
    ds_read_b64_tr_b16 v[136:137], v16 offset:2048
    ds_read_b64_tr_b16 v[138:139], v16 offset:2560
    s_add_u32 m0, s24, 98304
    s_add_u32 s61, s67, 0
    buffer_load_dwordx4 v11, s[44:47], s61 offen nt lds
    s_waitcnt vmcnt(6)
    s_add_u32 m0, s24, 99328
    s_add_u32 s61, s67, 0
    buffer_load_dwordx4 v12, s[44:47], s61 offen nt lds
    s_waitcnt vmcnt(6)
    s_add_u32 m0, s70, 4096
    s_add_u32 s61, s73, 229376
    buffer_load_dwordx4 v14, s[52:55], s61 offen  lds
    s_waitcnt vmcnt(6)
    s_add_u32 m0, s24, 106496
    s_add_u32 s61, s67, 262144
    buffer_load_dwordx4 v11, s[44:47], s61 offen nt lds
    s_waitcnt vmcnt(6)
    ds_read_b64_tr_b16 v[140:141], v16 offset:3072
    ds_read_b64_tr_b16 v[142:143], v16 offset:3584
    s_add_u32 m0, s24, 107520
    s_add_u32 s61, s67, 262144
    buffer_load_dwordx4 v12, s[44:47], s61 offen nt lds
    s_add_u32 m0, s0, 1000
    s_nop 0
    global_load_lds_dword v19, s[16:17] offset:24
    s_waitcnt vmcnt(7)
    s_add_u32 m0, s24, 114688
    s_add_u32 s61, s68, 0
    buffer_load_dwordx4 v11, s[44:47], s61 offen nt lds
    s_waitcnt vmcnt(6)
    s_add_u32 m0, s70, 5120
    s_add_u32 s61, s73, 236544
    buffer_load_dwordx4 v14, s[52:55], s61 offen  lds
    s_waitcnt vmcnt(6)
    s_add_u32 m0, s24, 115712
    s_add_u32 s61, s68, 0
    buffer_load_dwordx4 v12, s[44:47], s61 offen nt lds
    s_waitcnt vmcnt(6)
    ds_read_b64_tr_b16 v[144:145], v16 offset:4096
    ds_read_b64_tr_b16 v[146:147], v16 offset:4608
    s_add_u32 m0, s24, 122880
    s_add_u32 s61, s68, 262144
    buffer_load_dwordx4 v11, s[44:47], s61 offen nt lds
    s_waitcnt vmcnt(6)
    s_add_u32 m0, s24, 123904
    s_add_u32 s61, s68, 262144
    buffer_load_dwordx4 v12, s[44:47], s61 offen nt lds
    s_add_u32 m0, s0, 996
    s_nop 0
    global_load_lds_dword v19, s[16:17] offset:28
    s_waitcnt vmcnt(7)
    s_waitcnt lgkmcnt(8)
    s_add_u32 m0, s70, 0
    s_add_u32 s61, s73, 258048
    buffer_load_dwordx4 v14, s[52:55], s61 offen  lds
    s_waitcnt vmcnt(6)
    v_cmp_gt_u32 vcc, 9, v4
    s_cbranch_vccnz Ls_203
Lb_204:
    buffer_load_dwordx2 v[24:25], v18, s[32:35], 0 offen sc1
    s_add_u32 m0, s24, 16384
    s_add_u32 s61, s69, 0
    buffer_load_dwordx4 v11, s[44:47], s61 offen nt lds
    s_waitcnt vmcnt(7)
    ds_read_b64_tr_b16 v[148:149], v16 offset:5120
    ds_read_b64_tr_b16 v[150:151], v16 offset:5632
    s_add_u32 m0, s24, 17408
    s_add_u32 s61, s69, 0
    buffer_load_dwordx4 v12, s[44:47], s61 offen nt lds
    s_waitcnt vmcnt(7)
    s_add_u32 m0, s24, 24576
    s_add_u32 s61, s69, 262144
    buffer_load_dwordx4 v11, s[44:47], s61 offen nt lds
    s_waitcnt vmcnt(7)
    s_waitcnt lgkmcnt(8)
    s_add_u32 m0, s70, 1024
    s_add_u32 s61, s73, 265216
    buffer_load_dwordx4 v14, s[52:55], s61 offen  lds
    s_waitcnt vmcnt(7)
    s_add_u32 m0, s24, 25600
    s_add_u32 s61, s69, 262144
    buffer_load_dwordx4 v12, s[44:47], s61 offen nt lds
    s_add_u32 m0, s0, 992
    s_nop 0
    global_load_lds_dword v19, s[16:17] offset:32
    s_waitcnt vmcnt(5)
    ds_read_b64_tr_b16 v[152:153], v16 offset:0
    ds_read_b64_tr_b16 v[154:155], v16 offset:512
    s_xor_b32 s79, s22, 1
    s_lshl_b32 s79, s79, 7
    s_add_u32 s3, s76, s79
    s_add_u32 m0, s24, 32768
    s_add_u32 s61, s3, 0
    buffer_load_dwordx4 v13, s[48:51], s61 offen nt lds
    s_waitcnt vmcnt(5)
    s_add_u32 m0, s24, 33792
    s_add_u32 s61, s3, 131072
    buffer_load_dwordx4 v13, s[48:51], s61 offen nt lds
    s_add_u32 m0, s0, 2036
    s_nop 0
    global_load_lds_dword v19, s[16:17] offset:12
    s_waitcnt vmcnt(6)
Lc_205:
    v_xor_b32 v25, s29, v25
    v_and_b32 v3, 0xf0, v25
    v_cmp_ne_u32 vcc, 0, v3
    s_cmp_lg_u64 vcc, 0
    s_cselect_b32 s30, 1, 0
    v_and_b32 v25, 0xffffff0f, v25
    v_subrev_u32 v25, 3, v25
    v_cmp_lt_u32 s[60:61], 12, v25
    v_cmp_ne_u32 vcc, s26, v24
    s_or_b64 vcc, vcc, s[60:61]
    s_cbranch_vccnz Ls_206
Lb_207:
    s_add_u32 s3, s77, s79
    s_add_u32 m0, s24, 40960
    s_add_u32 s61, s3, 0
    buffer_load_dwordx4 v13, s[48:51], s61 offen nt lds
    s_waitcnt vmcnt(6)
    ds_read_b64_tr_b16 v[156:157], v16 offset:1024
    ds_read_b64_tr_b16 v[158:159], v16 offset:1536
    s_add_u32 m0, s24, 41984
    s_add_u32 s61, s3, 131072
    buffer_load_dwordx4 v13, s[48:51], s61 offen nt lds
    s_add_u32 m0, s0, 2032
    s_nop 0
    global_load_lds_dword v19, s[16:17] offset:16
    s_waitcnt vmcnt(7)
    v_cmp_gt_u32 vcc, 11, v4
    s_cbranch_vccnz Ls_210
Lb_211:
    s_xor_b32 s79, s22, 2
    s_lshl_b32 s79, s79, 7
    s_add_u32 s3, s74, s79
    s_add_u32 m0, s24, 49152
    s_add_u32 s61, s3, 0
    buffer_load_dwordx4 v13, s[48:51], s61 offen nt lds
    s_waitcnt vmcnt(6)
    s_add_u32 m0, s24, 50176
    s_add_u32 s61, s3, 131072
    buffer_load_dwordx4 v13, s[48:51], s61 offen nt lds
    s_add_u32 m0, s0, 2028
    s_nop 0
    global_load_lds_dword v19, s[16:17] offset:20
    s_waitcnt vmcnt(7)
    s_add_u32 s3, s75, s79
    s_add_u32 m0, s24, 57344
    s_add_u32 s61, s3, 0
    buffer_load_dwordx4 v13, s[48:51], s61 offen nt lds
    s_waitcnt vmcnt(6)
    s_add_u32 m0, s24, 58368
    s_add_u32 s61, s3, 131072
    buffer_load_dwordx4 v13, s[48:51], s61 offen nt lds
    s_add_u32 m0, s0, 2024
    s_nop 0
    global_load_lds_dword v19, s[16:17] offset:24
    s_waitcnt vmcnt(7)
    s_mov_b32 s56, s14
    s_and_b32 s57, s15, 0xffff
    s_mov_b32 s58, 458752
    s_mov_b32 s59, 0x00020000
    s_lshl_b32 s62, s22, 2
    s_add_u32 s62, s62, s23
    s_sub_u32 s62, s62, 11
    s_mul_i32 s12, s25, 18432
    s_mul_i32 s63, s23, 4608
    s_add_u32 s63, s63, 6291456
    s_add_u32 s12, s12, s63
    s_add_u32 s13, s12, 4096
    s_and_b32 s64, s25, 31
    s_mul_i32 s64, s64, 18432
    s_add_u32 s64, s64, s63
    s_lshl_b32 s63, s20, 6
    s_add_u32 s14, s64, s63
    s_lshl_b32 s63, s20, 9
    s_add_u32 s64, s64, s63
    s_add_u32 s4, s64, 0
    s_add_u32 s8, s14, 4096
    s_add_u32 s5, s64, 1179648
    s_add_u32 s9, s14, 1183744
    s_add_u32 s6, s64, 2359296
    s_add_u32 s10, s14, 2363392
    s_add_u32 s7, s64, 3538944
    s_add_u32 s11, s14, 3543040
    s_add_u32 s15, s26, 5
    s_lshl_b32 s64, s15, 2
    s_lshl_b32 s65, s21, 3
    s_add_u32 s65, s65, s20
    s_mul_i32 s65, s65, 7168
    s_add_u32 s65, s65, s31
    s_lshl_b32 s14, s23, 6
    s_add_u32 s65, s65, s14
    v_mov_b32 v8, s26
    v_mov_b32 v9, s27
    v_and_b32 v26, 15, v0
    v_lshlrev_b32 v26, 4, v26
    v_lshl_add_u32 v26, v23, 8, v26
    v_bfe_u32 v27, v0, 4, 1
    v_lshl_add_u32 v26, v27, 10, v26
    v_add_u32 v17, 32768, v26
    v_bfe_u32 v26, v0, 3, 2
    v_lshlrev_b32 v20, 9, v26
    v_lshl_add_u32 v20, v23, 7, v20
    v_lshl_add_u32 v20, v21, 4, v20
    v_lshlrev_b32 v27, 6, v26
    v_lshl_add_u32 v27, v23, 5, v27
    v_lshl_add_u32 v27, v21, 2, v27
    v_mul_u32_u24 v28, 589824, v23
    v_and_b32 v24, 15, v0
    v_lshl_add_u32 v29, v24, 2, v28
    v_and_b32 v24, 31, v0
    v_lshl_add_u32 v28, v24, 4, v28
    v_mul_u32_u24 v24, 896, v21
    v_lshl_add_u32 v23, v23, 3, v24
    v_bfe_u32 v26, v0, 3, 1
    v_lshl_add_u32 v23, v26, 5, v23
    v_bfe_u32 v26, v0, 4, 1
    v_lshl_add_u32 v23, v26, 4, v23
    s_add_u32 s3, s76, s79
    s_add_u32 m0, s24, 65536
    s_add_u32 s61, s3, 0
    buffer_load_dwordx4 v13, s[48:51], s61 offen nt lds
    s_waitcnt vmcnt(6)
    s_add_u32 m0, s24, 66560
    s_add_u32 s61, s3, 131072
    buffer_load_dwordx4 v13, s[48:51], s61 offen nt lds
    s_add_u32 m0, s0, 2020
    s_nop 0
    global_load_lds_dword v19, s[16:17] offset:28
    s_waitcnt vmcnt(7)
    s_add_u32 s3, s77, s79
    s_add_u32 m0, s24, 73728
    s_add_u32 s61, s3, 0
    buffer_load_dwordx4 v13, s[48:51], s61 offen nt lds
    s_waitcnt vmcnt(6)
    s_add_u32 m0, s24, 74752
    s_add_u32 s61, s3, 131072
    buffer_load_dwordx4 v13, s[48:51], s61 offen nt lds
    s_add_u32 m0, s0, 2016
    s_nop 0
    global_load_lds_dword v19, s[16:17] offset:32
    s_waitcnt vmcnt(7)
    v_cmp_gt_u32 vcc, 15, v4
    s_cbranch_vccnz Ls_212
Lb_213:
    s_xor_b32 s79, s22, 3
    s_lshl_b32 s79, s79, 7
    s_add_u32 s3, s74, s79
    s_add_u32 m0, s24, 81920
    s_add_u32 s61, s3, 0
    buffer_load_dwordx4 v13, s[48:51], s61 offen nt lds
    s_waitcnt vmcnt(6)
    s_add_u32 m0, s24, 82944
    s_add_u32 s61, s3, 131072
    buffer_load_dwordx4 v13, s[48:51], s61 offen nt lds
    s_add_u32 m0, s0, 2012
    s_nop 0
    global_load_lds_dword v19, s[16:17] offset:36
    s_waitcnt vmcnt(7)
    s_add_u32 s3, s75, s79
    s_add_u32 m0, s24, 90112
    s_add_u32 s61, s3, 0
    buffer_load_dwordx4 v13, s[48:51], s61 offen nt lds
    s_waitcnt vmcnt(6)
    s_add_u32 m0, s24, 91136
    s_add_u32 s61, s3, 131072
    buffer_load_dwordx4 v13, s[48:51], s61 offen nt lds
    s_add_u32 m0, s0, 2008
    s_nop 0
    global_load_lds_dword v19, s[16:17] offset:40
    s_waitcnt vmcnt(7)
    s_add_u32 s3, s76, s79
    s_add_u32 m0, s24, 98304
    s_add_u32 s61, s3, 0
    buffer_load_dwordx4 v13, s[48:51], s61 offen nt lds
    s_waitcnt vmcnt(6)
    s_add_u32 m0, s24, 99328
    s_add_u32 s61, s3, 131072
    buffer_load_dwordx4 v13, s[48:51], s61 offen nt lds
    s_add_u32 m0, s0, 2004
    s_nop 0
    global_load_lds_dword v19, s[16:17] offset:44
    s_waitcnt vmcnt(7)
    s_add_u32 s3, s77, s79
    s_add_u32 m0, s24, 106496
    s_add_u32 s61, s3, 0
    buffer_load_dwordx4 v13, s[48:51], s61 offen nt lds
    s_waitcnt vmcnt(6)
    s_add_u32 m0, s24, 107520
    s_add_u32 s61, s3, 131072
    buffer_load_dwordx4 v13, s[48:51], s61 offen nt lds
    s_add_u32 m0, s0, 2000
    s_nop 0
    global_load_lds_dword v19, s[16:17] offset:48
    s_waitcnt vmcnt(7)
    s_xor_b32 s79, s22, 0
    s_lshl_b32 s79, s79, 7
    s_add_u32 s3, s74, s79
    s_add_u32 m0, s24, 114688
    s_add_u32 s61, s3, 0
    buffer_load_dwordx4 v13, s[48:51], s61 offen nt lds
    s_waitcnt vmcnt(6)
    s_add_u32 m0, s24, 115712
    s_add_u32 s61, s3, 131072
    buffer_load_dwordx4 v13, s[48:51], s61 offen nt lds
    s_add_u32 m0, s0, 1996
    s_nop 0
    global_load_lds_dword v19, s[16:17] offset:52
    s_waitcnt vmcnt(7)
    s_add_u32 s3, s75, s79
    s_add_u32 m0, s24, 122880
    s_add_u32 s61, s3, 0
    buffer_load_dwordx4 v13, s[48:51], s61 offen nt lds
    s_waitcnt vmcnt(6)
    s_add_u32 m0, s24, 123904
    s_add_u32 s61, s3, 131072
    buffer_load_dwordx4 v13, s[48:51], s61 offen nt lds
    s_add_u32 m0, s0, 1992
    s_nop 0
    global_load_lds_dword v19, s[16:17] offset:56
    s_waitcnt vmcnt(7)
    s_add_u32 s3, s76, s79
    s_add_u32 m0, s24, 16384
    s_add_u32 s61, s3, 0
    buffer_load_dwordx4 v13, s[48:51], s61 offen nt lds
    s_waitcnt vmcnt(6)
    s_add_u32 m0, s24, 17408
    s_add_u32 s61, s3, 131072
    buffer_load_dwordx4 v13, s[48:51], s61 offen nt lds
    s_add_u32 m0, s0, 1988
    s_nop 0
    global_load_lds_dword v19, s[16:17] offset:60
    s_waitcnt vmcnt(7)
    s_add_u32 s3, s77, s79
    s_add_u32 m0, s24, 24576
    s_add_u32 s61, s3, 0
    buffer_load_dwordx4 v13, s[48:51], s61 offen nt lds
    s_waitcnt vmcnt(6)
    s_add_u32 m0, s24, 25600
    s_add_u32 s61, s3, 131072
    buffer_load_dwordx4 v13, s[48:51], s61 offen nt lds
    s_add_u32 m0, s0, 1984
    s_nop 0
    global_load_lds_dword v19, s[16:17] offset:64
    s_waitcnt vmcnt(7)
Ljoin:
    s_xor_b32 s61, s22, 1
    s_mul_i32 s61, s61, 57344
    s_add_u32 s61, s61, s72
    buffer_load_dword v15, v30, s[52:55], s61 offen
    s_waitcnt vmcnt(6)
    s_xor_b32 s61, s22, 2
    s_mul_i32 s61, s61, 57344
    s_add_u32 s61, s61, s72
    buffer_load_dword v15, v30, s[52:55], s61 offen
    s_waitcnt vmcnt(6)
    s_xor_b32 s61, s22, 3
    s_mul_i32 s61, s61, 57344
    s_add_u32 s61, s61, s72
    buffer_load_dword v15, v30, s[52:55], s61 offen
    s_waitcnt vmcnt(5)
    s_cmp_lt_u32 s62, 2
    s_cbranch_scc1 Lend
    s_waitcnt lgkmcnt(10)
    s_xor_b32 s73, s22, 1
    s_mul_i32 s73, s73, 57344
    s_add_u32 s73, s73, s78
    s_add_u32 m0, s70, 2048
    s_add_u32 s61, s73, 0
    buffer_load_dwordx4 v14, s[52:55], s61 offen  lds
    s_waitcnt vmcnt(5)
    s_waitcnt lgkmcnt(8)
    s_add_u32 m0, s70, 3072
    s_add_u32 s61, s73, 7168
    buffer_load_dwordx4 v14, s[52:55], s61 offen  lds
    s_waitcnt vmcnt(4)
    s_waitcnt lgkmcnt(6)
    s_add_u32 m0, s70, 4096
    s_add_u32 s61, s73, 28672
    buffer_load_dwordx4 v14, s[52:55], s61 offen  lds
    s_waitcnt vmcnt(4)
    s_waitcnt lgkmcnt(4)
    s_add_u32 m0, s70, 5120
    s_add_u32 s61, s73, 35840
    buffer_load_dwordx4 v14, s[52:55], s61 offen  lds
    s_waitcnt vmcnt(4)
    s_waitcnt lgkmcnt(2)
    s_add_u32 m0, s70, 0
    s_add_u32 s61, s73, 229376
    buffer_load_dwordx4 v14, s[52:55], s61 offen  lds
    s_waitcnt vmcnt(4)
    ds_read_b64_tr_b16 v[160:161], v16 offset:2048
    ds_read_b64_tr_b16 v[162:163], v16 offset:2560
    s_waitcnt lgkmcnt(2)
    s_add_u32 m0, s70, 1024
    s_add_u32 s61, s73, 236544
    buffer_load_dwordx4 v14, s[52:55], s61 offen  lds
    s_waitcnt vmcnt(4)
    ds_read_b64_tr_b16 v[164:165], v16 offset:3072
    ds_read_b64_tr_b16 v[166:167], v16 offset:3584
    s_waitcnt lgkmcnt(2)
    s_add_u32 m0, s70, 2048
    s_add_u32 s61, s73, 258048
    buffer_load_dwordx4 v14, s[52:55], s61 offen  lds
    s_waitcnt vmcnt(4)
    ds_read_b64_tr_b16 v[168:169], v16 offset:4096
    ds_read_b64_tr_b16 v[170:171], v16 offset:4608
    s_waitcnt lgkmcnt(2)
    s_add_u32 m0, s70, 3072
    s_add_u32 s61, s73, 265216
    buffer_load_dwordx4 v14, s[52:55], s61 offen  lds
    s_waitcnt vmcnt(4)
    ds_read_b64_tr_b16 v[172:173], v16 offset:5120
    ds_read_b64_tr_b16 v[174:175], v16 offset:5632
    s_waitcnt lgkmcnt(2)
    s_xor_b32 s73, s22, 2
    s_mul_i32 s73, s73, 57344
    s_add_u32 s73, s73, s78
    s_add_u32 m0, s70, 4096
    s_add_u32 s61, s73, 0
    buffer_load_dwordx4 v14, s[52:55], s61 offen  lds
    s_waitcnt vmcnt(4)
    ds_read_b64_tr_b16 v[176:177], v16 offset:0
    ds_read_b64_tr_b16 v[178:179], v16 offset:512
    s_waitcnt lgkmcnt(2)
    s_add_u32 m0, s70, 5120
    s_add_u32 s61, s73, 7168
    buffer_load_dwordx4 v14, s[52:55], s61 offen  lds
    s_waitcnt vmcnt(4)
    ds_read_b64_tr_b16 v[180:181], v16 offset:1024
    ds_read_b64_tr_b16 v[182:183], v16 offset:1536
    s_waitcnt lgkmcnt(2)
    s_add_u32 m0, s70, 0
    s_add_u32 s61, s73, 28672
    buffer_load_dwordx4 v14, s[52:55], s61 offen  lds
    s_waitcnt vmcnt(4)
    ds_read_b64_tr_b16 v[184:185], v16 offset:2048
    ds_read_b64_tr_b16 v[186:187], v16 offset:2560
    s_waitcnt lgkmcnt(2)
    s_add_u32 m0, s70, 1024
    s_add_u32 s61, s73, 35840
    buffer_load_dwordx4 v14, s[52:55], s61 offen  lds
    s_waitcnt vmcnt(4)
    ds_read_b64_tr_b16 v[188:189], v16 offset:3072
    ds_read_b64_tr_b16 v[190:191], v16 offset:3584
    s_waitcnt lgkmcnt(2)
    s_add_u32 m0, s70, 2048
    s_add_u32 s61, s73, 229376
    buffer_load_dwordx4 v14, s[52:55], s61 offen  lds
    s_waitcnt vmcnt(4)
    ds_read_b64_tr_b16 v[192:193], v16 offset:4096
    ds_read_b64_tr_b16 v[194:195], v16 offset:4608
    s_waitcnt lgkmcnt(2)
    s_add_u32 m0, s70, 3072
    s_add_u32 s61, s73, 236544
    buffer_load_dwordx4 v14, s[52:55], s61 offen  lds
    s_waitcnt vmcnt(4)
    ds_read_b64_tr_b16 v[196:197], v16 offset:5120
    ds_read_b64_tr_b16 v[198:199], v16 offset:5632
    s_waitcnt lgkmcnt(2)
    s_add_u32 m0, s70, 4096
    s_add_u32 s61, s73, 258048
    buffer_load_dwordx4 v14, s[52:55], s61 offen  lds
    s_waitcnt vmcnt(4)
    ds_read_b64_tr_b16 v[200:201], v16 offset:0
    ds_read_b64_tr_b16 v[202:203], v16 offset:512
    s_waitcnt lgkmcnt(2)
    s_add_u32 m0, s70, 5120
    s_add_u32 s61, s73, 265216
    buffer_load_dwordx4 v14, s[52:55], s61 offen  lds
    s_waitcnt vmcnt(4)
    ds_read_b64_tr_b16 v[204:205], v16 offset:1024
    ds_read_b64_tr_b16 v[206:207], v16 offset:1536
    s_waitcnt lgkmcnt(2)
    s_xor_b32 s73, s22, 3
    s_mul_i32 s73, s73, 57344
    s_add_u32 s73, s73, s78
    s_add_u32 m0, s70, 0
    s_add_u32 s61, s73, 0
    buffer_load_dwordx4 v14, s[52:55], s61 offen  lds
    s_waitcnt vmcnt(4)
    ds_read_b64_tr_b16 v[208:209], v16 offset:2048
    ds_read_b64_tr_b16 v[210:211], v16 offset:2560
    s_waitcnt lgkmcnt(2)
    s_add_u32 m0, s70, 1024
    s_add_u32 s61, s73, 7168
    buffer_load_dwordx4 v14, s[52:55], s61 offen  lds
    s_waitcnt vmcnt(4)
    ds_read_b64_tr_b16 v[212:213], v16 offset:3072
    ds_read_b64_tr_b16 v[214:215], v16 offset:3584
    s_waitcnt lgkmcnt(2)
    s_add_u32 m0, s70, 2048
    s_add_u32 s61, s73, 28672
    buffer_load_dwordx4 v14, s[52:55], s61 offen  lds
    s_waitcnt vmcnt(4)
    ds_read_b64_tr_b16 v[216:217], v16 offset:4096
    ds_read_b64_tr_b16 v[218:219], v16 offset:4608
    s_waitcnt lgkmcnt(2)
    s_add_u32 m0, s70, 3072
    s_add_u32 s61, s73, 35840
    buffer_load_dwordx4 v14, s[52:55], s61 offen  lds
    s_waitcnt vmcnt(4)
    ds_read_b64_tr_b16 v[220:221], v16 offset:5120
    ds_read_b64_tr_b16 v[222:223], v16 offset:5632
    s_waitcnt lgkmcnt(2)
    s_add_u32 m0, s70, 4096
    s_add_u32 s61, s73, 229376
    buffer_load_dwordx4 v14, s[52:55], s61 offen  lds
    s_waitcnt vmcnt(4)
    ds_read_b64_tr_b16 v[224:225], v16 offset:0
    ds_read_b64_tr_b16 v[226:227], v16 offset:512
    s_waitcnt lgkmcnt(2)
    s_add_u32 m0, s70, 5120
    s_add_u32 s61, s73, 236544
    buffer_load_dwordx4 v14, s[52:55], s61 offen  lds
    s_waitcnt vmcnt(4)
    ds_read_b64_tr_b16 v[228:229], v16 offset:1024
    ds_read_b64_tr_b16 v[230:231], v16 offset:1536
    s_waitcnt lgkmcnt(2)
    s_add_u32 m0, s70, 0
    s_add_u32 s61, s73, 258048
    buffer_load_dwordx4 v14, s[52:55], s61 offen  lds
    s_waitcnt vmcnt(4)
    ds_read_b64_tr_b16 v[232:233], v16 offset:2048
    ds_read_b64_tr_b16 v[234:235], v16 offset:2560
    s_waitcnt lgkmcnt(2)
    s_add_u32 m0, s70, 1024
    s_add_u32 s61, s73, 265216
    buffer_load_dwordx4 v14, s[52:55], s61 offen  lds
    s_waitcnt vmcnt(4)
    ds_read_b64_tr_b16 v[236:237], v16 offset:3072
    ds_read_b64_tr_b16 v[238:239], v16 offset:3584
Li_214:
    s_sub_u32 s28, s28, 1
    s_cbranch_scc1 Lx_215
    ds_read_b32 v7, v1 offset:5120
    s_waitcnt lgkmcnt(0)
    v_cmp_gt_u32 vcc, 1, v7
    s_cbranch_vccnz Li_214
Ld_216:
    ds_read_b128 v[64:67], v17 offset:0
    ds_read_b128 v[68:71], v17 offset:4096
    ds_read_b128 v[72:75], v17 offset:512
    ds_read_b128 v[76:79], v17 offset:4608
    ds_read_b128 v[80:83], v17 offset:2048
    ds_read_b128 v[84:87], v17 offset:6144
    s_waitcnt lgkmcnt(5)
    v_mfma_f32_32x32x16_bf16 v[32:47], v[128:131], v[64:67], 0
    ds_read_b128 v[88:91], v17 offset:2560
    s_waitcnt lgkmcnt(4)
    v_mfma_f32_32x32x16_bf16 v[48:63], v[128:131], v[68:71], 0
    ds_read_b128 v[92:95], v17 offset:6656
    v_mfma_f32_32x32x16_bf16 v[32:47], v[132:135], v[72:75], v[32:47]
    ds_read_b128 v[64:67], v17 offset:8192
    s_waitcnt lgkmcnt(4)
    v_mfma_f32_32x32x16_bf16 v[48:63], v[132:135], v[76:79], v[48:63]
    ds_read_b128 v[68:71], v17 offset:12288
    v_mfma_f32_32x32x16_bf16 v[32:47], v[136:139], v[80:83], v[32:47]
    ds_read_b128 v[72:75], v17 offset:8704
    s_waitcnt lgkmcnt(4)
    v_mfma_f32_32x32x16_bf16 v[48:63], v[136:139], v[84:87], v[48:63]
    ds_read_b128 v[76:79], v17 offset:12800
    v_mfma_f32_32x32x16_bf16 v[32:47], v[140:143], v[88:91], v[32:47]
    ds_read_b128 v[80:83], v17 offset:10240
    s_waitcnt lgkmcnt(4)
    v_mfma_f32_32x32x16_bf16 v[48:63], v[140:143], v[92:95], v[48:63]
    ds_read_b128 v[84:87], v17 offset:14336
    v_mfma_f32_32x32x16_bf16 v[32:47], v[144:147], v[64:67], v[32:47]
    ds_read_b128 v[88:91], v17 offset:10752
    s_waitcnt lgkmcnt(4)
    s_waitcnt vmcnt(3)
    ds_read_b64_tr_b16 v[240:241], v16 offset:4096
    ds_read_b64_tr_b16 v[242:243], v16 offset:4608
    s_waitcnt vmcnt(2)
    ds_read_b64_tr_b16 v[244:245], v16 offset:5120
    ds_read_b64_tr_b16 v[246:247], v16 offset:5632
    s_waitcnt vmcnt(1)
    ds_read_b64_tr_b16 v[248:249], v16 offset:0
    ds_read_b64_tr_b16 v[250:251], v16 offset:512
    s_waitcnt vmcnt(0)
    ds_read_b64_tr_b16 v[252:253], v16 offset:1024
    ds_read_b64_tr_b16 v[254:255], v16 offset:1536
    v_mfma_f32_32x32x16_bf16 v[48:63], v[144:147], v[68:71], v[48:63]
    ds_read_b128 v[92:95], v17 offset:14848
    v_mfma_f32_32x32x16_bf16 v[32:47], v[148:151], v[72:75], v[32:47]
    s_waitcnt lgkmcnt(11)
    v_mfma_f32_32x32x16_bf16 v[48:63], v[148:151], v[76:79], v[48:63]
    v_mfma_f32_32x32x16_bf16 v[32:47], v[152:155], v[80:83], v[32:47]
    s_waitcnt lgkmcnt(9)
    v_mfma_f32_32x32x16_bf16 v[48:63], v[152:155], v[84:87], v[48:63]
    v_mfma_f32_32x32x16_bf16 v[32:47], v[156:159], v[88:91], v[32:47]
    s_waitcnt lgkmcnt(0)
    v_mfma_f32_32x32x16_bf16 v[48:63], v[156:159], v[92:95], v[48:63]
Li_217:
    s_sub_u32 s28, s28, 1
    s_cbranch_scc1 Lx_218
    ds_read_b32 v6, v1 offset:3072
    s_waitcnt lgkmcnt(0)
    v_cmp_gt_u32 vcc, 1, v6
    s_cbranch_vccnz Li_217
Ld_219:
    ds_read_b128 v[64:67], v17 offset:16384
    ds_read_b128 v[68:71], v17 offset:20480
    ds_read_b128 v[72:75], v17 offset:16896
    ds_read_b128 v[76:79], v17 offset:20992
    ds_read_b128 v[80:83], v17 offset:18432
    ds_read_b128 v[84:87], v17 offset:22528
    s_waitcnt lgkmcnt(5)
    v_mfma_f32_32x32x16_bf16 v[32:47], v[160:163], v[64:67], v[32:47]
    ds_read_b128 v[88:91], v17 offset:18944
    s_waitcnt lgkmcnt(4)
    v_mfma_f32_32x32x16_bf16 v[48:63], v[160:163], v[68:71], v[48:63]
    ds_read_b128 v[92:95], v17 offset:23040
    v_mfma_f32_32x32x16_bf16 v[32:47], v[164:167], v[72:75], v[32:47]
    ds_read_b128 v[64:67], v17 offset:24576
    s_waitcnt lgkmcnt(4)
    v_mfma_f32_32x32x16_bf16 v[48:63], v[164:167], v[76:79], v[48:63]
    ds_read_b32 v6, v1 offset:3072
    ds_read_b128 v[68:71], v17 offset:28672
    v_mfma_f32_32x32x16_bf16 v[32:47], v[168:171], v[80:83], v[32:47]
    ds_read_b128 v[72:75], v17 offset:25088
    s_waitcnt lgkmcnt(5)
    v_mfma_f32_32x32x16_bf16 v[48:63], v[168:171], v[84:87], v[48:63]
    ds_read_b128 v[76:79], v17 offset:29184
    v_mfma_f32_32x32x16_bf16 v[32:47], v[172:175], v[88:91], v[32:47]
    ds_read_b128 v[80:83], v17 offset:26624
    s_waitcnt lgkmcnt(5)
    v_mfma_f32_32x32x16_bf16 v[48:63], v[172:175], v[92:95], v[48:63]
    ds_read_b128 v[84:87], v17 offset:30720
    v_mfma_f32_32x32x16_bf16 v[32:47], v[176:179], v[64:67], v[32:47]
    ds_read_b128 v[88:91], v17 offset:27136
    s_waitcnt lgkmcnt(4)
    v_mfma_f32_32x32x16_bf16 v[48:63], v[176:179], v[68:71], v[48:63]
    ds_read_b128 v[92:95], v17 offset:31232
    v_cmp_gt_u32 vcc, 2, v6
    s_cbranch_vccnz Ls_220
Lb_221:
    v_mfma_f32_32x32x16_bf16 v[32:47], v[180:183], v[72:75], v[32:47]
    ds_read_b128 v[64:67], v17 offset:32768
    s_waitcnt lgkmcnt(4)
    v_mfma_f32_32x32x16_bf16 v[48:63], v[180:183], v[76:79], v[48:63]
    ds_read_b32 v6, v1 offset:3072
    ds_read_b128 v[68:71], v17 offset:33280
    v_mfma_f32_32x32x16_bf16 v[32:47], v[184:187], v[80:83], v[32:47]
    ds_read_b128 v[72:75], v17 offset:34816
    s_waitcnt lgkmcnt(5)
    v_mfma_f32_32x32x16_bf16 v[48:63], v[184:187], v[84:87], v[48:63]
    ds_read_b128 v[76:79], v17 offset:35328
    v_mfma_f32_32x32x16_bf16 v[32:47], v[188:191], v[88:91], v[32:47]
    ds_read_b128 v[80:83], v17 offset:40960
    s_waitcnt lgkmcnt(5)
    v_mfma_f32_32x32x16_bf16 v[48:63], v[188:191], v[92:95], v[48:63]
    ds_read_b128 v[84:87], v17 offset:41472
    v_mfma_f32_32x32x16_bf16 v[32:47], v[192:195], v[64:67], v[32:47]
    ds_read_b128 v[88:91], v17 offset:43008
    s_waitcnt lgkmcnt(4)
    v_mfma_f32_32x32x16_bf16 v[32:47], v[196:199], v[68:71], v[32:47]
    ds_read_b128 v[92:95], v17 offset:43520
    v_cmp_gt_u32 vcc, 3, v6
    s_cbranch_vccnz Ls_222
Lb_223:
    v_mfma_f32_32x32x16_bf16 v[32:47], v[200:203], v[72:75], v[32:47]
    ds_read_b128 v[64:67], v17 offset:49152
    s_waitcnt lgkmcnt(4)
    v_mfma_f32_32x32x16_bf16 v[32:47], v[204:207], v[76:79], v[32:47]
    ds_read_b128 v[68:71], v17 offset:49664
    v_mfma_f32_32x32x16_bf16 v[32:47], v[208:211], v[80:83], v[32:47]
    ds_read_b128 v[72:75], v17 offset:51200
    s_waitcnt lgkmcnt(4)
    v_mfma_f32_32x32x16_bf16 v[32:47], v[212:215], v[84:87], v[32:47]
    ds_read_b128 v[76:79], v17 offset:51712
    v_mfma_f32_32x32x16_bf16 v[32:47], v[216:219], v[88:91], v[32:47]
    ds_read_b128 v[80:83], v17 offset:57344
    s_waitcnt lgkmcnt(4)
    v_mfma_f32_32x32x16_bf16 v[32:47], v[220:223], v[92:95], v[32:47]
    ds_read_b128 v[84:87], v17 offset:57856
    v_mfma_f32_32x32x16_bf16 v[32:47], v[224:227], v[64:67], v[32:47]
    ds_read_b128 v[88:91], v17 offset:59392
    s_waitcnt lgkmcnt(4)
    v_mfma_f32_32x32x16_bf16 v[32:47], v[228:231], v[68:71], v[32:47]
    ds_read_b128 v[92:95], v17 offset:59904
    v_mfma_f32_32x32x16_bf16 v[32:47], v[232:235], v[72:75], v[32:47]
    ds_read_b128 v[64:67], v17 offset:36864
    s_waitcnt lgkmcnt(4)
    v_mfma_f32_32x32x16_bf16 v[32:47], v[236:239], v[76:79], v[32:47]
    ds_read_b128 v[68:71], v17 offset:37376
    v_mfma_f32_32x32x16_bf16 v[32:47], v[240:243], v[80:83], v[32:47]
    ds_read_b128 v[72:75], v17 offset:38912
    s_waitcnt lgkmcnt(4)
    v_mfma_f32_32x32x16_bf16 v[32:47], v[244:247], v[84:87], v[32:47]
    ds_read_b128 v[76:79], v17 offset:39424
    v_mfma_f32_32x32x16_bf16 v[32:47], v[248:251], v[88:91], v[32:47]
    ds_read_b128 v[80:83], v17 offset:45056
    s_waitcnt lgkmcnt(4)
    v_mfma_f32_32x32x16_bf16 v[32:47], v[252:255], v[92:95], v[32:47]
    ds_read_b128 v[84:87], v17 offset:45568
    v_mfma_f32_32x32x16_bf16 v[48:63], v[192:195], v[64:67], v[48:63]
    ds_read_b128 v[88:91], v17 offset:47104
    s_waitcnt lgkmcnt(4)
    v_mfma_f32_32x32x16_bf16 v[48:63], v[196:199], v[68:71], v[48:63]
    ds_read_b128 v[92:95], v17 offset:47616
    v_mfma_f32_32x32x16_bf16 v[48:63], v[200:203], v[72:75], v[48:63]
    ds_read_b128 v[64:67], v17 offset:53248
    s_waitcnt lgkmcnt(4)
    v_mfma_f32_32x32x16_bf16 v[48:63], v[204:207], v[76:79], v[48:63]
    ds_read_b128 v[68:71], v17 offset:53760
    v_mfma_f32_32x32x16_bf16 v[48:63], v[208:211], v[80:83], v[48:63]
    ds_read_b128 v[72:75], v17 offset:55296
    s_waitcnt lgkmcnt(4)
    v_cvt_pk_bf16_f32 v96, v32, v33
    v_cvt_pk_bf16_f32 v97, v34, v35
    v_cvt_pk_bf16_f32 v98, v36, v37
    v_cvt_pk_bf16_f32 v99, v38, v39
    buffer_store_dwordx4 v[96:99], v20, s[32:35], s12 offen offset:0 sc1
    v_mfma_f32_32x32x16_bf16 v[48:63], v[212:215], v[84:87], v[48:63]
    ds_read_b128 v[76:79], v17 offset:55808
    v_mfma_f32_32x32x16_bf16 v[48:63], v[216:219], v[88:91], v[48:63]
    ds_read_b128 v[80:83], v17 offset:61440
    s_waitcnt lgkmcnt(4)
    v_cvt_pk_bf16_f32 v100, v40, v41
    v_cvt_pk_bf16_f32 v101, v42, v43
    v_cvt_pk_bf16_f32 v102, v44, v45
    v_cvt_pk_bf16_f32 v103, v46, v47
    buffer_store_dwordx4 v[100:103], v20, s[32:35], s12 offen offset:256 sc1
    v_mfma_f32_32x32x16_bf16 v[48:63], v[220:223], v[92:95], v[48:63]
    ds_read_b128 v[84:87], v17 offset:61952
    v_mfma_f32_32x32x16_bf16 v[48:63], v[224:227], v[64:67], v[48:63]
    ds_read_b128 v[88:91], v17 offset:63488
    s_waitcnt lgkmcnt(4)
    v_add3_u32 v10, v96, v97, s15
    v_add3_u32 v10, v10, v98, v99
    v_add3_u32 v10, v10, v100, v101
    v_add3_u32 v10, v10, v102, v103
    buffer_store_dword v10, v27, s[32:35], s13 offen offset:0 sc1
    v_mfma_f32_32x32x16_bf16 v[48:63], v[228:231], v[68:71], v[48:63]
    ds_read_b128 v[92:95], v17 offset:64000
    v_mfma_f32_32x32x16_bf16 v[48:63], v[232:235], v[72:75], v[48:63]
    s_waitcnt lgkmcnt(3)
    v_mfma_f32_32x32x16_bf16 v[48:63], v[236:239], v[76:79], v[48:63]
    v_mfma_f32_32x32x16_bf16 v[48:63], v[240:243], v[80:83], v[48:63]
    s_waitcnt lgkmcnt(1)
    v_mfma_f32_32x32x16_bf16 v[48:63], v[244:247], v[84:87], v[48:63]
    v_mfma_f32_32x32x16_bf16 v[48:63], v[248:251], v[88:91], v[48:63]
    s_waitcnt lgkmcnt(0)
    v_mfma_f32_32x32x16_bf16 v[48:63], v[252:255], v[92:95], v[48:63]
    s_nop 11
    v_cvt_pk_bf16_f32 v104, v48, v49
    v_cvt_pk_bf16_f32 v105, v50, v51
    v_cvt_pk_bf16_f32 v106, v52, v53
    v_cvt_pk_bf16_f32 v107, v54, v55
    buffer_store_dwordx4 v[104:107], v20, s[32:35], s12 offen offset:2048 sc1
    v_cvt_pk_bf16_f32 v108, v56, v57
    v_cvt_pk_bf16_f32 v109, v58, v59
    v_cvt_pk_bf16_f32 v110, v60, v61
    v_cvt_pk_bf16_f32 v111, v62, v63
    buffer_store_dwordx4 v[108:111], v20, s[32:35], s12 offen offset:2304 sc1
    v_add3_u32 v11, v104, v105, s15
    v_add3_u32 v11, v11, v106, v107
    v_add3_u32 v11, v11, v108, v109
    v_add3_u32 v11, v11, v110, v111
    buffer_store_dword v11, v27, s[32:35], s13 offen offset:256 sc1
    s_waitcnt vmcnt(0)
Lfp:
    buffer_load_dwordx4 v[64:67], v28, s[32:35], s4 offen sc1
    buffer_load_dword v12, v29, s[32:35], s8 offen sc1
    buffer_load_dwordx4 v[68:71], v28, s[32:35], s5 offen sc1
    buffer_load_dword v13, v29, s[32:35], s9 offen sc1
    buffer_load_dwordx4 v[72:75], v28, s[32:35], s6 offen sc1
    buffer_load_dword v14, v29, s[32:35], s10 offen sc1
    buffer_load_dwordx4 v[76:79], v28, s[32:35], s7 offen sc1
    buffer_load_dword v15, v29, s[32:35], s11 offen sc1
    s_waitcnt vmcnt(7)
    v_add_u32 v10, v64, v65
    v_add3_u32 v10, v10, v66, v67
    v_lshlrev_b32 v32, 16, v64
    v_and_b32 v33, 0xffff0000, v64
    v_lshlrev_b32 v34, 16, v65
    v_and_b32 v35, 0xffff0000, v65
    v_lshlrev_b32 v36, 16, v66
    v_and_b32 v37, 0xffff0000, v66
    v_lshlrev_b32 v38, 16, v67
    v_and_b32 v39, 0xffff0000, v67
    s_waitcnt vmcnt(5)
    v_add3_u32 v10, v10, v68, v69
    v_add3_u32 v10, v10, v70, v71
    v_lshlrev_b32 v16, 16, v68
    v_and_b32 v17, 0xffff0000, v68
    v_pk_add_f32 v[32:33], v[32:33], v[16:17]
    v_lshlrev_b32 v16, 16, v69
    v_and_b32 v17, 0xffff0000, v69
    v_pk_add_f32 v[34:35], v[34:35], v[16:17]
    v_lshlrev_b32 v16, 16, v70
    v_and_b32 v17, 0xffff0000, v70
    v_pk_add_f32 v[36:37], v[36:37], v[16:17]
    v_lshlrev_b32 v16, 16, v71
    v_and_b32 v17, 0xffff0000, v71
    v_pk_add_f32 v[38:39], v[38:39], v[16:17]
    s_waitcnt vmcnt(3)
    v_add3_u32 v10, v10, v72, v73
    v_add3_u32 v10, v10, v74, v75
    v_lshlrev_b32 v16, 16, v72
    v_and_b32 v17, 0xffff0000, v72
    v_pk_add_f32 v[32:33], v[32:33], v[16:17]
    v_lshlrev_b32 v16, 16, v73
    v_and_b32 v17, 0xffff0000, v73
    v_pk_add_f32 v[34:35], v[34:35], v[16:17]
    v_lshlrev_b32 v16, 16, v74
    v_and_b32 v17, 0xffff0000, v74
    v_pk_add_f32 v[36:37], v[36:37], v[16:17]
    v_lshlrev_b32 v16, 16, v75
    v_and_b32 v17, 0xffff0000, v75
    v_pk_add_f32 v[38:39], v[38:39], v[16:17]
    s_waitcnt vmcnt(1)
    v_add3_u32 v10, v10, v76, v77
    v_add3_u32 v10, v10, v78, v79
    v_mov_b32 v11, v10
    v_lshlrev_b32 v16, 16, v76
    v_and_b32 v17, 0xffff0000, v76
    v_pk_add_f32 v[32:33], v[32:33], v[16:17]
    v_lshlrev_b32 v16, 16, v77
    v_and_b32 v17, 0xffff0000, v77
    v_pk_add_f32 v[34:35], v[34:35], v[16:17]
    v_lshlrev_b32 v16, 16, v78
    v_and_b32 v17, 0xffff0000, v78
    v_pk_add_f32 v[36:37], v[36:37], v[16:17]
    v_lshlrev_b32 v16, 16, v79
    v_and_b32 v17, 0xffff0000, v79
    v_pk_add_f32 v[38:39], v[38:39], v[16:17]
    v_permlane16_swap_b32 v10, v11
    s_waitcnt vmcnt(0)
    v_add3_u32 v12, v12, v13, v14
    v_add_u32 v12, v12, v15
    v_add3_u32 v10, v10, v11, s64
    v_cmp_ne_u32 vcc, v10, v12
    v_permlane32_swap_b32 v32, v36
    v_permlane32_swap_b32 v33, v37
    v_permlane32_swap_b32 v34, v38
    v_permlane32_swap_b32 v35, v39
    s_cbranch_vccnz Ls_224
Lb_225:
    v_pk_add_f32 v[32:33], v[32:33], v[36:37]
    v_pk_add_f32 v[34:35], v[34:35], v[38:39]
    v_cvt_pk_bf16_f32 v12, v32, v33
    v_cvt_pk_bf16_f32 v13, v34, v35
    buffer_store_dwordx2 v[12:13], v23, s[56:59], s65 offen
    s_or_b32 s60, s20, s22
    s_or_b32 s60, s60, s23
    s_cbranch_scc1 Lend
    s_lshl_b32 s61, s21, 7
    s_mov_b64 exec, 1
    buffer_store_dwordx2 v[8:9], off, s[32:35], s61
    s_mov_b64 exec, -1
Lend:
    s_endpgm
Ls_168:
    ds_read_b32 v4, v1 offset:4096
    s_waitcnt lgkmcnt(0)
    v_cmp_gt_u32 vcc, 1, v4
    s_cbranch_vccz Lb_169
    s_sleep 1
    s_sub_u32 s28, s28, 1
    s_cbranch_scc0 Ls_168
    s_mov_b32 s28, 0
    s_branch Lb_169
Ls_170:
    ds_read_b32 v4, v1 offset:4096
    s_waitcnt lgkmcnt(0)
    v_cmp_gt_u32 vcc, 2, v4
    s_cbranch_vccz Lb_171
    s_sleep 1
    s_sub_u32 s28, s28, 1
    s_cbranch_scc0 Ls_170
    s_mov_b32 s28, 0
    s_branch Lb_171
Ls_172:
    ds_read_b32 v6, v1 offset:0
    s_waitcnt lgkmcnt(0)
    v_cmp_gt_u32 vcc, 6, v6
    s_cbranch_vccz Lb_173
    s_sleep 1
    s_sub_u32 s28, s28, 1
    s_cbranch_scc0 Ls_172
    s_mov_b32 s28, 0
    s_branch Lb_173
Ls_174:
    ds_read_b32 v4, v1 offset:4096
    s_waitcnt lgkmcnt(0)
    v_cmp_gt_u32 vcc, 5, v4
    s_cbranch_vccz Lb_175
    s_sleep 1
    s_sub_u32 s28, s28, 1
    s_cbranch_scc0 Ls_174
    s_mov_b32 s28, 0
    s_branch Lb_175
Ls_176:
    ds_read_b32 v4, v1 offset:4096
    s_waitcnt lgkmcnt(0)
    v_cmp_gt_u32 vcc, 5, v4
    s_cbranch_vccz Lb_177
    s_sleep 1
    s_sub_u32 s28, s28, 1
    s_cbranch_scc0 Ls_176
    s_mov_b32 s28, 0
    s_branch Lb_177
Ls_178:
    ds_read_b32 v4, v1 offset:4096
    s_waitcnt lgkmcnt(0)
    v_cmp_gt_u32 vcc, 7, v4
    s_cbranch_vccz Lb_179
    s_sleep 1
    s_sub_u32 s28, s28, 1
    s_cbranch_scc0 Ls_178
    s_mov_b32 s28, 0
    s_branch Lb_179
Ls_180:
    ds_read_b32 v4, v1 offset:4096
    s_waitcnt lgkmcnt(0)
    v_cmp_gt_u32 vcc, 9, v4
    s_cbranch_vccz Lb_181
    s_sleep 1
    s_sub_u32 s28, s28, 1
    s_cbranch_scc0 Ls_180
    s_mov_b32 s28, 0
    s_branch Lb_181
Ls_185:
    buffer_inv sc1
    s_waitcnt vmcnt(0)
    s_branch Lb_186
Ls_183:
    s_cmp_lg_u32 s30, 0
    s_cbranch_scc1 Ls_185
Lb_186:
    buffer_load_dwordx2 v[24:25], v18, s[32:35], 0 offen sc1
    s_waitcnt vmcnt(0)
    s_sub_u32 s28, s28, 1
    s_cbranch_scc0 Lc_182
    s_mov_b32 s28, 0
    s_branch Lb_184
Ls_187:
    ds_read_b32 v4, v1 offset:4096
    s_waitcnt lgkmcnt(0)
    v_cmp_gt_u32 vcc, 11, v4
    s_cbranch_vccz Lb_188
    s_sleep 1
    s_sub_u32 s28, s28, 1
    s_cbranch_scc0 Ls_187
    s_mov_b32 s28, 0
    s_branch Lb_188
Ls_189:
    ds_read_b32 v4, v1 offset:4096
    s_waitcnt lgkmcnt(0)
    v_cmp_gt_u32 vcc, 15, v4
    s_cbranch_vccz Lb_190
    s_sleep 1
    s_sub_u32 s28, s28, 1
    s_cbranch_scc0 Ls_189
    s_mov_b32 s28, 0
    s_branch Lb_190
Ls_191:
    ds_read_b32 v4, v1 offset:4096
    s_waitcnt lgkmcnt(0)
    v_cmp_gt_u32 vcc, 1, v4
    s_cbranch_vccz Lb_192
    s_sleep 1
    s_sub_u32 s28, s28, 1
    s_cbranch_scc0 Ls_191
    s_mov_b32 s28, 0
    s_branch Lb_192
Ls_193:
    ds_read_b32 v4, v1 offset:4096
    s_waitcnt lgkmcnt(0)
    v_cmp_gt_u32 vcc, 2, v4
    s_cbranch_vccz Lb_194
    s_sleep 1
    s_sub_u32 s28, s28, 1
    s_cbranch_scc0 Ls_193
    s_mov_b32 s28, 0
    s_branch Lb_194
Ls_195:
    ds_read_b32 v6, v1 offset:0
    s_waitcnt lgkmcnt(0)
    v_cmp_gt_u32 vcc, 6, v6
    s_cbranch_vccz Lb_196
    s_sleep 1
    s_sub_u32 s28, s28, 1
    s_cbranch_scc0 Ls_195
    s_mov_b32 s28, 0
    s_branch Lb_196
Ls_197:
    ds_read_b32 v4, v1 offset:4096
    s_waitcnt lgkmcnt(0)
    v_cmp_gt_u32 vcc, 5, v4
    s_cbranch_vccz Lb_198
    s_sleep 1
    s_sub_u32 s28, s28, 1
    s_cbranch_scc0 Ls_197
    s_mov_b32 s28, 0
    s_branch Lb_198
Ls_199:
    ds_read_b32 v4, v1 offset:4096
    s_waitcnt lgkmcnt(0)
    v_cmp_gt_u32 vcc, 5, v4
    s_cbranch_vccz Lb_200
    s_sleep 1
    s_sub_u32 s28, s28, 1
    s_cbranch_scc0 Ls_199
    s_mov_b32 s28, 0
    s_branch Lb_200
Ls_201:
    ds_read_b32 v4, v1 offset:4096
    s_waitcnt lgkmcnt(0)
    v_cmp_gt_u32 vcc, 7, v4
    s_cbranch_vccz Lb_202
    s_sleep 1
    s_sub_u32 s28, s28, 1
    s_cbranch_scc0 Ls_201
    s_mov_b32 s28, 0
    s_branch Lb_202
Ls_203:
    ds_read_b32 v4, v1 offset:4096
    s_waitcnt lgkmcnt(0)
    v_cmp_gt_u32 vcc, 9, v4
    s_cbranch_vccz Lb_204
    s_sleep 1
    s_sub_u32 s28, s28, 1
    s_cbranch_scc0 Ls_203
    s_mov_b32 s28, 0
    s_branch Lb_204
Ls_208:
    buffer_inv sc1
    s_waitcnt vmcnt(0)
    s_branch Lb_209
Ls_206:
    s_cmp_lg_u32 s30, 0
    s_cbranch_scc1 Ls_208
Lb_209:
    buffer_load_dwordx2 v[24:25], v18, s[32:35], 0 offen sc1
    s_waitcnt vmcnt(0)
    s_sub_u32 s28, s28, 1
    s_cbranch_scc0 Lc_205
    s_mov_b32 s28, 0
    s_branch Lb_207
Ls_210:
    ds_read_b32 v4, v1 offset:4096
    s_waitcnt lgkmcnt(0)
    v_cmp_gt_u32 vcc, 11, v4
    s_cbranch_vccz Lb_211
    s_sleep 1
    s_sub_u32 s28, s28, 1
    s_cbranch_scc0 Ls_210
    s_mov_b32 s28, 0
    s_branch Lb_211
Ls_212:
    ds_read_b32 v4, v1 offset:4096
    s_waitcnt lgkmcnt(0)
    v_cmp_gt_u32 vcc, 15, v4
    s_cbranch_vccz Lb_213
    s_sleep 1
    s_sub_u32 s28, s28, 1
    s_cbranch_scc0 Ls_212
    s_mov_b32 s28, 0
    s_branch Lb_213
Lx_215:
    s_mov_b32 s28, 0
    s_branch Ld_216
Lx_218:
    s_mov_b32 s28, 0
    s_branch Ld_219
Ls_220:
    ds_read_b32 v6, v1 offset:3072
    s_waitcnt lgkmcnt(0)
    v_cmp_gt_u32 vcc, 2, v6
    s_cbranch_vccz Lb_221
    s_sub_u32 s28, s28, 1
    s_cbranch_scc0 Ls_220
    s_mov_b32 s28, 0
    s_branch Lb_221
Ls_222:
    ds_read_b32 v6, v1 offset:3072
    s_waitcnt lgkmcnt(0)
    v_cmp_gt_u32 vcc, 3, v6
    s_cbranch_vccz Lb_223
    s_sub_u32 s28, s28, 1
    s_cbranch_scc0 Ls_222
    s_mov_b32 s28, 0
    s_branch Lb_223
Ls_224:
    s_sub_u32 s28, s28, 1
    s_cbranch_scc0 Lfp
    s_mov_b32 s28, 0
    s_branch Lb_225
Lcompute:
    ds_write_b32 v2, v4 offset:3072
    ds_write_b32 v2, v4 offset:4096
    ds_write_b32 v2, v4 offset:5120
    s_lshl_b32 s59, s25, 2
    s_add_u32 s59, s59, s23
    s_lshl_b32 s44, s59, 10
    s_add_u32 s44, s44, 1048576
    v_min_u32 v10, 5, v0
    v_lshlrev_b32 v10, 7, v10
    s_waitcnt lgkmcnt(0)
    s_load_dwordx2 s[26:27], s[18:19], s3
    s_mov_b32 s32, s18
    s_and_b32 s33, s19, 0xffff
    s_mov_b32 s34, 268435456
    s_mov_b32 s35, 0x00020000
    buffer_load_dword v31, v10, s[32:35], s44 offen
    s_getpc_b64 s[16:17]
Lt_1:
    s_add_u32 s16, s16, Ltable-Lt_1
    s_addc_u32 s17, s17, 0
    s_lshl_b32 s0, s23, 8
    s_add_u32 s0, s0, 155648
    v_and_b32 v20, 3, v0
    v_lshlrev_b32 v20, 8, v20
    v_lshl_add_u32 v20, v0, 2, v20
    v_add_u32 v1, 155648, v20
    v_bfe_u32 v20, v0, 2, 2
    v_lshrrev_b32 v21, 4, v0
    v_lshl_add_u32 v22, v21, 3, v20
    v_lshlrev_b32 v22, 8, v22
    v_and_b32 v23, 3, v0
    v_lshl_add_u32 v22, v23, 3, v22
    v_add_u32 v22, 90112, v22
    v_bfe_u32 v20, v0, 2, 3
    s_and_b32 s60, s23, 2
    s_lshl_b32 s60, s60, 1
    s_or_b32 s61, s60, 0
    v_xor_b32 v23, s61, v20
    v_lshl_add_u32 v46, v23, 5, v22
    s_or_b32 s61, s60, 1
    v_xor_b32 v23, s61, v20
    v_lshl_add_u32 v47, v23, 5, v22
    s_or_b32 s61, s60, 2
    v_xor_b32 v23, s61, v20
    v_lshl_add_u32 v48, v23, 5, v22
    s_or_b32 s61, s60, 3
    v_xor_b32 v23, s61, v20
    v_lshl_add_u32 v49, v23, 5, v22
    v_and_b32 v24, 15, v0
    s_and_b32 s60, s23, 1
    s_lshl_b32 s60, s60, 12
    s_add_u32 s60, s60, 81920
    v_lshl_add_u32 v22, v24, 7, s60
    v_bfe_u32 v20, v0, 1, 3
    v_add_u32 v23, 0, v21
    v_xor_b32 v23, v23, v20
    v_lshl_add_u32 v50, v23, 4, v22
    v_add_u32 v23, 4, v21
    v_xor_b32 v23, v23, v20
    v_lshl_add_u32 v51, v23, 4, v22
    v_subrev_u32 v40, 49152, v46
    v_add_u32 v52, 49152, v46
    v_subrev_u32 v41, 49152, v47
    v_add_u32 v53, 49152, v47
    v_subrev_u32 v42, 49152, v48
    v_add_u32 v54, 49152, v48
    v_subrev_u32 v43, 49152, v49
    v_add_u32 v55, 49152, v49
    v_subrev_u32 v44, 49152, v50
    v_add_u32 v56, 49152, v50
    v_subrev_u32 v45, 49152, v51
    v_add_u32 v57, 49152, v51
    v_and_b32 v20, 3, v0
    v_max_u32 v20, 1, v20
    v_xor_b32 v20, s25, v20
    v_lshlrev_b32 v20, 2, v20
    v_add_u32 v20, s23, v20
    v_lshlrev_b32 v20, 10, v20
    v_add_u32 v28, 1049216, v20
    s_xor_b32 s58, s59, 0
    s_lshl_b32 s66, s58, 12
    s_add_u32 s66, s66, 2097152
    s_xor_b32 s58, s59, 4
    s_lshl_b32 s67, s58, 12
    s_add_u32 s67, s67, 2097152
    s_lshl_b32 s45, s58, 10
    s_add_u32 s45, s45, 1048576
    s_xor_b32 s58, s59, 8
    s_lshl_b32 s68, s58, 12
    s_add_u32 s68, s68, 2097152
    s_lshl_b32 s46, s58, 10
    s_add_u32 s46, s46, 1048576
    s_xor_b32 s58, s59, 12
    s_lshl_b32 s69, s58, 12
    s_add_u32 s69, s69, 2097152
    s_lshl_b32 s47, s58, 10
    s_add_u32 s47, s47, 1048576
    v_lshlrev_b32 v5, 4, v0
    v_lshlrev_b32 v23, 2, v0
    v_and_b32 v22, 15, v0
    v_lshrrev_b32 v20, 5, v0
    v_lshl_add_u32 v6, v20, 4, v22
    v_mul_u32_u24 v6, 12, v6
    s_mov_b32 s40, 0x41200000
    s_mov_b32 s42, 1035512379
    s_mov_b32 s43, 0
    v_lshrrev_b32 v21, 4, v0
    v_add_u32 v20, 0, v21
    v_xor_b32 v20, v20, v22
    v_lshlrev_b32 v20, 4, v20
    v_lshl_add_u32 v20, v22, 9, v20
    v_add_u32 v10, 16384, v20
    v_add_u32 v20, 4, v21
    v_xor_b32 v20, v20, v22
    v_lshlrev_b32 v20, 4, v20
    v_lshl_add_u32 v20, v22, 9, v20
    v_add_u32 v11, 16384, v20
    v_add_u32 v20, 8, v21
    v_xor_b32 v20, v20, v22
    v_lshlrev_b32 v20, 4, v20
    v_lshl_add_u32 v20, v22, 9, v20
    v_add_u32 v12, 16384, v20
    v_add_u32 v20, 12, v21
    v_xor_b32 v20, v20, v22
    v_lshlrev_b32 v20, 4, v20
    v_lshl_add_u32 v20, v22, 9, v20
    v_add_u32 v13, 16384, v20
    v_lshrrev_b32 v20, 2, v0
    v_lshlrev_b32 v20, 7, v20
    v_and_b32 v22, 3, v0
    v_lshl_add_u32 v20, v22, 3, v20
    v_bfe_u32 v22, v0, 3, 2
    v_xor_b32 v21, 0, v22
    v_lshl_add_u32 v14, v21, 5, v20
    v_xor_b32 v21, 1, v22
    v_lshl_add_u32 v15, v21, 5, v20
    v_xor_b32 v21, 2, v22
    v_lshl_add_u32 v16, v21, 5, v20
    v_xor_b32 v21, 3, v22
    v_lshl_add_u32 v17, v21, 5, v20
    s_barrier
    s_waitcnt lgkmcnt(0)
    s_add_u32 s26, s26, 0x6b43a9b5
    s_add_u32 s27, s27, 0x3c6ef300
    s_and_b32 s27, s27, 0xffffff00
    s_getreg_b32 s60, hwreg(HW_REG_XCC_ID, 0, 4)
    s_lshl_b32 s60, s60, 4
    s_or_b32 s29, s27, s60
    s_add_u32 s52, s26, 0
    s_add_u32 s53, s26, 1
    s_add_u32 s54, s26, 2
    s_add_u32 s55, s26, 3
    v_cmp_gt_u32 vcc, 1, v4
    s_cbranch_vccnz Ls_2
Lb_3:
    s_waitcnt vmcnt(0)
    s_or_b32 s60, s29, 1
    v_mov_b32 v30, s26
    v_mov_b32 v31, s60
    s_mov_b64 exec, 1
    buffer_store_dwordx2 v[30:31], off, s[32:35], s44 offset:640
    s_mov_b64 exec, -1
    s_cmp_lg_u32 s30, 0
    s_cbranch_scc1 Ls_4
Lb_5:
    ds_read_b128 v[192:195], v50 offset:0
    ds_read_b128 v[196:199], v50 offset:2048
    ds_read_b64_tr_b16 v[160:161], v46 offset:0
    ds_read_b64_tr_b16 v[162:163], v46 offset:1024
    ds_read_b64_tr_b16 v[164:165], v47 offset:0
    ds_read_b64_tr_b16 v[166:167], v47 offset:1024
    ds_read_b64_tr_b16 v[168:169], v48 offset:0
    ds_read_b64_tr_b16 v[170:171], v48 offset:1024
    ds_read_b32 v4, v1 offset:0
    ds_read_b64_tr_b16 v[172:173], v49 offset:0
    ds_read_b64_tr_b16 v[174:175], v49 offset:1024
    s_waitcnt lgkmcnt(7)
    v_mfma_f32_16x16x32_bf16 v[128:131], v[160:163], v[192:195], 0
    ds_read_b128 v[200:203], v51 offset:0
    ds_read_b128 v[204:207], v51 offset:2048
    ds_read_b64_tr_b16 v[176:177], v46 offset:8192
    ds_read_b64_tr_b16 v[178:179], v46 offset:9216
    v_mfma_f32_16x16x32_bf16 v[136:139], v[160:163], v[196:199], 0
    s_waitcnt lgkmcnt(9)
    v_mfma_f32_16x16x32_bf16 v[132:135], v[164:167], v[192:195], 0
    ds_read_b64_tr_b16 v[180:181], v47 offset:8192
    ds_read_b64_tr_b16 v[182:183], v47 offset:9216
    v_mfma_f32_16x16x32_bf16 v[140:143], v[164:167], v[196:199], 0
    s_waitcnt lgkmcnt(9)
    v_mfma_f32_16x16x32_bf16 v[144:147], v[168:171], v[192:195], 0
    ds_read_b64_tr_b16 v[184:185], v48 offset:8192
    ds_read_b64_tr_b16 v[186:187], v48 offset:9216
    v_mfma_f32_16x16x32_bf16 v[152:155], v[168:171], v[196:199], 0
    s_waitcnt lgkmcnt(8)
    v_mfma_f32_16x16x32_bf16 v[148:151], v[172:175], v[192:195], 0
    ds_read_b64_tr_b16 v[188:189], v49 offset:8192
    ds_read_b64_tr_b16 v[190:191], v49 offset:9216
    v_mfma_f32_16x16x32_bf16 v[156:159], v[172:175], v[196:199], 0
    s_waitcnt lgkmcnt(6)
    v_cmp_gt_u32 vcc, 2, v4
    s_cbranch_vccnz Ls_6
Lb_7:
    v_mfma_f32_16x16x32_bf16 v[128:131], v[176:179], v[200:203], v[128:131]
    ds_read_b128 v[208:211], v50 offset:24576
    ds_read_b128 v[212:215], v50 offset:26624
    ds_read_b64_tr_b16 v[160:161], v46 offset:24576
    ds_read_b64_tr_b16 v[162:163], v46 offset:25600
    v_mfma_f32_16x16x32_bf16 v[136:139], v[176:179], v[204:207], v[136:139]
    s_waitcnt lgkmcnt(8)
    v_mfma_f32_16x16x32_bf16 v[132:135], v[180:183], v[200:203], v[132:135]
    ds_read_b64_tr_b16 v[164:165], v47 offset:24576
    ds_read_b64_tr_b16 v[166:167], v47 offset:25600
    v_mfma_f32_16x16x32_bf16 v[140:143], v[180:183], v[204:207], v[140:143]
    s_waitcnt lgkmcnt(8)
    v_mfma_f32_16x16x32_bf16 v[144:147], v[184:187], v[200:203], v[144:147]
    ds_read_b64_tr_b16 v[168:169], v48 offset:24576
    ds_read_b64_tr_b16 v[170:171], v48 offset:25600
    v_mfma_f32_16x16x32_bf16 v[152:155], v[184:187], v[204:207], v[152:155]
    s_waitcnt lgkmcnt(8)
    v_mfma_f32_16x16x32_bf16 v[148:151], v[188:191], v[200:203], v[148:151]
    ds_read_b32 v4, v1 offset:0
    ds_read_b64_tr_b16 v[172:173], v49 offset:24576
    ds_read_b64_tr_b16 v[174:175], v49 offset:25600
    v_mfma_f32_16x16x32_bf16 v[156:159], v[188:191], v[204:207], v[156:159]
    s_waitcnt lgkmcnt(7)
    s_add_u32 m0, s0, 4092
    s_nop 0
    global_load_lds_dword v7, s[16:17] offset:4
    v_mfma_f32_16x16x32_bf16 v[128:131], v[160:163], v[208:211], v[128:131]
    ds_read_b128 v[216:219], v51 offset:24576
    ds_read_b128 v[220:223], v51 offset:26624
    ds_read_b64_tr_b16 v[176:177], v46 offset:32768
    ds_read_b64_tr_b16 v[178:179], v46 offset:33792
    v_mfma_f32_16x16x32_bf16 v[136:139], v[160:163], v[212:215], v[136:139]
    s_waitcnt lgkmcnt(9)
    v_mfma_f32_16x16x32_bf16 v[132:135], v[164:167], v[208:211], v[132:135]
    ds_read_b64_tr_b16 v[180:181], v47 offset:32768
    ds_read_b64_tr_b16 v[182:183], v47 offset:33792
    v_mfma_f32_16x16x32_bf16 v[140:143], v[164:167], v[212:215], v[140:143]
    s_waitcnt lgkmcnt(9)
    v_mfma_f32_16x16x32_bf16 v[144:147], v[168:171], v[208:211], v[144:147]
    ds_read_b64_tr_b16 v[184:185], v48 offset:32768
    ds_read_b64_tr_b16 v[186:187], v48 offset:33792
    v_mfma_f32_16x16x32_bf16 v[152:155], v[168:171], v[212:215], v[152:155]
    s_waitcnt lgkmcnt(8)
    v_mfma_f32_16x16x32_bf16 v[148:151], v[172:175], v[208:211], v[148:151]
    ds_read_b64_tr_b16 v[188:189], v49 offset:32768
    ds_read_b64_tr_b16 v[190:191], v49 offset:33792
    v_mfma_f32_16x16x32_bf16 v[156:159], v[172:175], v[212:215], v[156:159]
    s_waitcnt lgkmcnt(6)
    v_cmp_gt_u32 vcc, 3, v4
    s_cbranch_vccnz Ls_8
Lb_9:
    v_mfma_f32_16x16x32_bf16 v[128:131], v[176:179], v[216:219], v[128:131]
    ds_read_b128 v[192:195], v44 offset:0
    ds_read_b128 v[196:199], v44 offset:2048
    ds_read_b64_tr_b16 v[160:161], v40 offset:0
    ds_read_b64_tr_b16 v[162:163], v40 offset:1024
    v_mfma_f32_16x16x32_bf16 v[136:139], v[176:179], v[220:223], v[136:139]
    s_waitcnt lgkmcnt(8)
    v_mfma_f32_16x16x32_bf16 v[132:135], v[180:183], v[216:219], v[132:135]
    ds_read_b64_tr_b16 v[164:165], v41 offset:0
    ds_read_b64_tr_b16 v[166:167], v41 offset:1024
    v_mfma_f32_16x16x32_bf16 v[140:143], v[180:183], v[220:223], v[140:143]
    s_waitcnt lgkmcnt(8)
    v_mfma_f32_16x16x32_bf16 v[144:147], v[184:187], v[216:219], v[144:147]
    ds_read_b64_tr_b16 v[168:169], v42 offset:0
    ds_read_b64_tr_b16 v[170:171], v42 offset:1024
    v_mfma_f32_16x16x32_bf16 v[152:155], v[184:187], v[220:223], v[152:155]
    s_waitcnt lgkmcnt(8)
    v_mfma_f32_16x16x32_bf16 v[148:151], v[188:191], v[216:219], v[148:151]
    ds_read_b32 v4, v1 offset:0
    ds_read_b64_tr_b16 v[172:173], v43 offset:0
    ds_read_b64_tr_b16 v[174:175], v43 offset:1024
    v_mfma_f32_16x16x32_bf16 v[156:159], v[188:191], v[220:223], v[156:159]
    s_waitcnt lgkmcnt(7)
    s_add_u32 m0, s0, 4088
    s_nop 0
    global_load_lds_dword v7, s[16:17] offset:8
    v_mfma_f32_16x16x32_bf16 v[128:131], v[160:163], v[192:195], v[128:131]
    ds_read_b128 v[200:203], v45 offset:0
    ds_read_b128 v[204:207], v45 offset:2048
    ds_read_b64_tr_b16 v[176:177], v40 offset:8192
    ds_read_b64_tr_b16 v[178:179], v40 offset:9216
    v_mfma_f32_16x16x32_bf16 v[136:139], v[160:163], v[196:199], v[136:139]
    s_waitcnt lgkmcnt(9)
    v_mfma_f32_16x16x32_bf16 v[132:135], v[164:167], v[192:195], v[132:135]
    ds_read_b64_tr_b16 v[180:181], v41 offset:8192
    ds_read_b64_tr_b16 v[182:183], v41 offset:9216
    v_mfma_f32_16x16x32_bf16 v[140:143], v[164:167], v[196:199], v[140:143]
    s_waitcnt lgkmcnt(9)
    v_mfma_f32_16x16x32_bf16 v[144:147], v[168:171], v[192:195], v[144:147]
    ds_read_b64_tr_b16 v[184:185], v42 offset:8192
    ds_read_b64_tr_b16 v[186:187], v42 offset:9216
    v_mfma_f32_16x16x32_bf16 v[152:155], v[168:171], v[196:199], v[152:155]
    s_waitcnt lgkmcnt(8)
    v_mfma_f32_16x16x32_bf16 v[148:151], v[172:175], v[192:195], v[148:151]
    ds_read_b64_tr_b16 v[188:189], v43 offset:8192
    ds_read_b64_tr_b16 v[190:191], v43 offset:9216
    v_mfma_f32_16x16x32_bf16 v[156:159], v[172:175], v[196:199], v[156:159]
    s_waitcnt lgkmcnt(6)
    v_cmp_gt_u32 vcc, 4, v4
    s_cbranch_vccnz Ls_10
Lb_11:
    v_mfma_f32_16x16x32_bf16 v[128:131], v[176:179], v[200:203], v[128:131]
    ds_read_b128 v[208:211], v44 offset:24576
    ds_read_b128 v[212:215], v44 offset:26624
    ds_read_b64_tr_b16 v[160:161], v40 offset:24576
    ds_read_b64_tr_b16 v[162:163], v40 offset:25600
    v_mfma_f32_16x16x32_bf16 v[136:139], v[176:179], v[204:207], v[136:139]
    s_waitcnt lgkmcnt(8)
    v_mfma_f32_16x16x32_bf16 v[132:135], v[180:183], v[200:203], v[132:135]
    ds_read_b64_tr_b16 v[164:165], v41 offset:24576
    ds_read_b64_tr_b16 v[166:167], v41 offset:25600
    v_mfma_f32_16x16x32_bf16 v[140:143], v[180:183], v[204:207], v[140:143]
    s_waitcnt lgkmcnt(8)
    v_mfma_f32_16x16x32_bf16 v[144:147], v[184:187], v[200:203], v[144:147]
    ds_read_b64_tr_b16 v[168:169], v42 offset:24576
    ds_read_b64_tr_b16 v[170:171], v42 offset:25600
    v_mfma_f32_16x16x32_bf16 v[152:155], v[184:187], v[204:207], v[152:155]
    s_waitcnt lgkmcnt(8)
    v_mfma_f32_16x16x32_bf16 v[148:151], v[188:191], v[200:203], v[148:151]
    ds_read_b32 v4, v1 offset:0
    ds_read_b64_tr_b16 v[172:173], v43 offset:24576
    ds_read_b64_tr_b16 v[174:175], v43 offset:25600
    v_mfma_f32_16x16x32_bf16 v[156:159], v[188:191], v[204:207], v[156:159]
    s_waitcnt lgkmcnt(7)
    v_mfma_f32_16x16x32_bf16 v[128:131], v[160:163], v[208:211], v[128:131]
    ds_read_b128 v[216:219], v45 offset:24576
    ds_read_b128 v[220:223], v45 offset:26624
    ds_read_b64_tr_b16 v[176:177], v40 offset:32768
    ds_read_b64_tr_b16 v[178:179], v40 offset:33792
    v_mfma_f32_16x16x32_bf16 v[136:139], v[160:163], v[212:215], v[136:139]
    s_waitcnt lgkmcnt(9)
    v_mfma_f32_16x16x32_bf16 v[132:135], v[164:167], v[208:211], v[132:135]
    ds_read_b64_tr_b16 v[180:181], v41 offset:32768
    ds_read_b64_tr_b16 v[182:183], v41 offset:33792
    v_mfma_f32_16x16x32_bf16 v[140:143], v[164:167], v[212:215], v[140:143]
    s_waitcnt lgkmcnt(9)
    v_mfma_f32_16x16x32_bf16 v[144:147], v[168:171], v[208:211], v[144:147]
    ds_read_b64_tr_b16 v[184:185], v42 offset:32768
    ds_read_b64_tr_b16 v[186:187], v42 offset:33792
    v_mfma_f32_16x16x32_bf16 v[152:155], v[168:171], v[212:215], v[152:155]
    s_waitcnt lgkmcnt(8)
    v_mfma_f32_16x16x32_bf16 v[148:151], v[172:175], v[208:211], v[148:151]
    ds_read_b64_tr_b16 v[188:189], v43 offset:32768
    ds_read_b64_tr_b16 v[190:191], v43 offset:33792
    v_mfma_f32_16x16x32_bf16 v[156:159], v[172:175], v[212:215], v[156:159]
    s_waitcnt lgkmcnt(6)
    v_cmp_gt_u32 vcc, 5, v4
    s_cbranch_vccnz Ls_12
Lb_13:
    buffer_load_dwordx2 v[26:27], v28, s[32:35], 0 offen sc1
    v_mfma_f32_16x16x32_bf16 v[128:131], v[176:179], v[216:219], v[128:131]
    ds_read_b128 v[192:195], v56 offset:0
    ds_read_b128 v[196:199], v56 offset:2048
    ds_read_b64_tr_b16 v[160:161], v52 offset:0
    ds_read_b64_tr_b16 v[162:163], v52 offset:1024
    v_mfma_f32_16x16x32_bf16 v[136:139], v[176:179], v[220:223], v[136:139]
    s_waitcnt lgkmcnt(8)
    v_mfma_f32_16x16x32_bf16 v[132:135], v[180:183], v[216:219], v[132:135]
    ds_read_b64_tr_b16 v[164:165], v53 offset:0
    ds_read_b64_tr_b16 v[166:167], v53 offset:1024
    v_mfma_f32_16x16x32_bf16 v[140:143], v[180:183], v[220:223], v[140:143]
    s_waitcnt lgkmcnt(8)
    v_mfma_f32_16x16x32_bf16 v[144:147], v[184:187], v[216:219], v[144:147]
    ds_read_b64_tr_b16 v[168:169], v54 offset:0
    ds_read_b64_tr_b16 v[170:171], v54 offset:1024
    v_mfma_f32_16x16x32_bf16 v[152:155], v[184:187], v[220:223], v[152:155]
    s_waitcnt lgkmcnt(8)
    v_mfma_f32_16x16x32_bf16 v[148:151], v[188:191], v[216:219], v[148:151]
    ds_read_b32 v4, v1 offset:0
    ds_read_b64_tr_b16 v[172:173], v55 offset:0
    ds_read_b64_tr_b16 v[174:175], v55 offset:1024
    v_mfma_f32_16x16x32_bf16 v[156:159], v[188:191], v[220:223], v[156:159]
    s_waitcnt lgkmcnt(7)
    v_mfma_f32_16x16x32_bf16 v[128:131], v[160:163], v[192:195], v[128:131]
    ds_read_b128 v[200:203], v57 offset:0
    ds_read_b128 v[204:207], v57 offset:2048
    ds_read_b64_tr_b16 v[176:177], v52 offset:8192
    ds_read_b64_tr_b16 v[178:179], v52 offset:9216
    v_mfma_f32_16x16x32_bf16 v[136:139], v[160:163], v[196:199], v[136:139]
    s_waitcnt lgkmcnt(9)
    v_mfma_f32_16x16x32_bf16 v[132:135], v[164:167], v[192:195], v[132:135]
    ds_read_b64_tr_b16 v[180:181], v53 offset:8192
    ds_read_b64_tr_b16 v[182:183], v53 offset:9216
    v_mfma_f32_16x16x32_bf16 v[140:143], v[164:167], v[196:199], v[140:143]
    s_waitcnt lgkmcnt(9)
    v_mfma_f32_16x16x32_bf16 v[144:147], v[168:171], v[192:195], v[144:147]
    ds_read_b64_tr_b16 v[184:185], v54 offset:8192
    ds_read_b64_tr_b16 v[186:187], v54 offset:9216
    v_mfma_f32_16x16x32_bf16 v[152:155], v[168:171], v[196:199], v[152:155]
    s_waitcnt lgkmcnt(8)
    v_mfma_f32_16x16x32_bf16 v[148:151], v[172:175], v[192:195], v[148:151]
    ds_read_b64_tr_b16 v[188:189], v55 offset:8192
    ds_read_b64_tr_b16 v[190:191], v55 offset:9216
    v_mfma_f32_16x16x32_bf16 v[156:159], v[172:175], v[196:199], v[156:159]
    s_waitcnt lgkmcnt(6)
    v_cmp_gt_u32 vcc, 6, v4
    s_cbranch_vccnz Ls_14
Lb_15:
    v_mfma_f32_16x16x32_bf16 v[128:131], v[176:179], v[200:203], v[128:131]
    ds_read_b128 v[208:211], v50 offset:0
    ds_read_b128 v[212:215], v50 offset:2048
    ds_read_b64_tr_b16 v[160:161], v46 offset:0
    ds_read_b64_tr_b16 v[162:163], v46 offset:1024
    v_mfma_f32_16x16x32_bf16 v[136:139], v[176:179], v[204:207], v[136:139]
    s_waitcnt lgkmcnt(8)
    v_mfma_f32_16x16x32_bf16 v[132:135], v[180:183], v[200:203], v[132:135]
    ds_read_b64_tr_b16 v[164:165], v47 offset:0
    ds_read_b64_tr_b16 v[166:167], v47 offset:1024
    v_mfma_f32_16x16x32_bf16 v[140:143], v[180:183], v[204:207], v[140:143]
    s_waitcnt lgkmcnt(8)
    v_mfma_f32_16x16x32_bf16 v[144:147], v[184:187], v[200:203], v[144:147]
    ds_read_b64_tr_b16 v[168:169], v48 offset:0
    ds_read_b64_tr_b16 v[170:171], v48 offset:1024
    v_mfma_f32_16x16x32_bf16 v[152:155], v[184:187], v[204:207], v[152:155]
    s_waitcnt lgkmcnt(8)
    v_mfma_f32_16x16x32_bf16 v[148:151], v[188:191], v[200:203], v[148:151]
    ds_read_b32 v4, v1 offset:0
    ds_read_b64_tr_b16 v[172:173], v49 offset:0
    ds_read_b64_tr_b16 v[174:175], v49 offset:1024
    v_mfma_f32_16x16x32_bf16 v[156:159], v[188:191], v[204:207], v[156:159]
    s_waitcnt lgkmcnt(7)
    s_add_u32 m0, s0, 4076
    s_nop 0
    global_load_lds_dword v7, s[16:17] offset:20
    v_mfma_f32_16x16x32_bf16 v[128:131], v[160:163], v[208:211], v[128:131]
    ds_read_b128 v[216:219], v51 offset:0
    ds_read_b128 v[220:223], v51 offset:2048
    ds_read_b64_tr_b16 v[176:177], v46 offset:8192
    ds_read_b64_tr_b16 v[178:179], v46 offset:9216
    v_mfma_f32_16x16x32_bf16 v[136:139], v[160:163], v[212:215], v[136:139]
    s_waitcnt lgkmcnt(9)
    v_mfma_f32_16x16x32_bf16 v[132:135], v[164:167], v[208:211], v[132:135]
    ds_read_b64_tr_b16 v[180:181], v47 offset:8192
    ds_read_b64_tr_b16 v[182:183], v47 offset:9216
    v_mfma_f32_16x16x32_bf16 v[140:143], v[164:167], v[212:215], v[140:143]
    s_waitcnt lgkmcnt(9)
    v_mfma_f32_16x16x32_bf16 v[144:147], v[168:171], v[208:211], v[144:147]
    ds_read_b64_tr_b16 v[184:185], v48 offset:8192
    ds_read_b64_tr_b16 v[186:187], v48 offset:9216
    v_mfma_f32_16x16x32_bf16 v[152:155], v[168:171], v[212:215], v[152:155]
    s_waitcnt lgkmcnt(8)
    v_mfma_f32_16x16x32_bf16 v[148:151], v[172:175], v[208:211], v[148:151]
    ds_read_b64_tr_b16 v[188:189], v49 offset:8192
    ds_read_b64_tr_b16 v[190:191], v49 offset:9216
    v_mfma_f32_16x16x32_bf16 v[156:159], v[172:175], v[212:215], v[156:159]
    s_waitcnt lgkmcnt(6)
    s_waitcnt vmcnt(1)
Lc_16:
    v_xor_b32 v27, s29, v27
    v_and_b32 v3, 0xf0, v27
    v_cmp_ne_u32 vcc, 0, v3
    s_cmp_lg_u64 vcc, 0
    s_cselect_b32 s30, 1, 0
    v_and_b32 v27, 0xffffff0f, v27
    v_subrev_u32 v27, 1, v27
    v_cmp_lt_u32 s[60:61], 14, v27
    v_cmp_ne_u32 vcc, s26, v26
    s_or_b64 vcc, vcc, s[60:61]
    s_cbranch_vccnz Ls_17
Lb_18:
    v_cmp_gt_u32 vcc, 7, v4
    s_cbranch_vccnz Ls_20
Lb_21:
    v_mfma_f32_16x16x32_bf16 v[128:131], v[176:179], v[216:219], v[128:131]
    ds_read_b128 v[192:195], v50 offset:24576
    ds_read_b128 v[196:199], v50 offset:26624
    ds_read_b64_tr_b16 v[160:161], v46 offset:24576
    ds_read_b64_tr_b16 v[162:163], v46 offset:25600
    v_mfma_f32_16x16x32_bf16 v[136:139], v[176:179], v[220:223], v[136:139]
    s_waitcnt lgkmcnt(8)
    v_mfma_f32_16x16x32_bf16 v[132:135], v[180:183], v[216:219], v[132:135]
    ds_read_b64_tr_b16 v[164:165], v47 offset:24576
    ds_read_b64_tr_b16 v[166:167], v47 offset:25600
    v_mfma_f32_16x16x32_bf16 v[140:143], v[180:183], v[220:223], v[140:143]
    s_waitcnt lgkmcnt(8)
    v_mfma_f32_16x16x32_bf16 v[144:147], v[184:187], v[216:219], v[144:147]
    ds_read_b128 v[200:203], v51 offset:24576
    ds_read_b128 v[204:207], v51 offset:26624
    ds_read_b64_tr_b16 v[168:169], v46 offset:32768
    ds_read_b64_tr_b16 v[170:171], v46 offset:33792
    v_mfma_f32_16x16x32_bf16 v[152:155], v[184:187], v[220:223], v[152:155]
    s_waitcnt lgkmcnt(10)
    v_mfma_f32_16x16x32_bf16 v[148:151], v[188:191], v[216:219], v[148:151]
    ds_read_b64_tr_b16 v[172:173], v47 offset:32768
    ds_read_b64_tr_b16 v[174:175], v47 offset:33792
    v_mfma_f32_16x16x32_bf16 v[156:159], v[188:191], v[220:223], v[156:159]
    s_waitcnt lgkmcnt(8)
    v_mfma_f32_16x16x32_bf16 v[128:131], v[160:163], v[192:195], v[128:131]
    ds_read_b64_tr_b16 v[176:177], v48 offset:24576
    ds_read_b64_tr_b16 v[178:179], v48 offset:25600
    v_mfma_f32_16x16x32_bf16 v[136:139], v[160:163], v[196:199], v[136:139]
    s_waitcnt lgkmcnt(8)
    v_mfma_f32_16x16x32_bf16 v[132:135], v[164:167], v[192:195], v[132:135]
    ds_read_b64_tr_b16 v[180:181], v49 offset:24576
    ds_read_b64_tr_b16 v[182:183], v49 offset:25600
    v_mfma_f32_16x16x32_bf16 v[140:143], v[164:167], v[196:199], v[140:143]
    s_waitcnt lgkmcnt(6)
    v_mfma_f32_16x16x32_bf16 v[128:131], v[168:171], v[200:203], v[128:131]
    ds_read_b64_tr_b16 v[184:185], v48 offset:32768
    ds_read_b64_tr_b16 v[186:187], v48 offset:33792
    v_mfma_f32_16x16x32_bf16 v[136:139], v[168:171], v[204:207], v[136:139]
    s_waitcnt lgkmcnt(6)
    v_mfma_f32_16x16x32_bf16 v[132:135], v[172:175], v[200:203], v[132:135]
    ds_read_b64_tr_b16 v[188:189], v49 offset:32768
    ds_read_b64_tr_b16 v[190:191], v49 offset:33792
    v_mfma_f32_16x16x32_bf16 v[140:143], v[172:175], v[204:207], v[140:143]
    s_waitcnt lgkmcnt(6)
    v_mfma_f32_16x16x32_bf16 v[144:147], v[176:179], v[192:195], v[144:147]
    v_mfma_f32_16x16x32_bf16 v[152:155], v[176:179], v[196:199], v[152:155]
    s_waitcnt lgkmcnt(4)
    v_mfma_f32_16x16x32_bf16 v[148:151], v[180:183], v[192:195], v[148:151]
    v_mfma_f32_16x16x32_bf16 v[156:159], v[180:183], v[196:199], v[156:159]
    s_waitcnt lgkmcnt(2)
    v_mfma_f32_16x16x32_bf16 v[144:147], v[184:187], v[200:203], v[144:147]
    v_mfma_f32_16x16x32_bf16 v[152:155], v[184:187], v[204:207], v[152:155]
    s_waitcnt lgkmcnt(0)
    v_mfma_f32_16x16x32_bf16 v[148:151], v[188:191], v[200:203], v[148:151]
    v_mfma_f32_16x16x32_bf16 v[156:159], v[188:191], v[204:207], v[156:159]
    s_add_u32 m0, s0, 4068
    s_nop 0
    global_load_lds_dword v7, s[16:17] offset:28
    v_mov_b32 v4, 0
    v_mov_b32 v30, s42
    v_pk_mul_f32 v[128:129], v[128:129], v[30:31] op_sel_hi:[1,0]
    v_pk_mul_f32 v[130:131], v[130:131], v[30:31] op_sel_hi:[1,0]
    v_pk_mul_f32 v[132:133], v[132:133], v[30:31] op_sel_hi:[1,0]
    v_pk_mul_f32 v[134:135], v[134:135], v[30:31] op_sel_hi:[1,0]
    v_pk_mul_f32 v[136:137], v[136:137], v[30:31] op_sel_hi:[1,0]
    v_pk_mul_f32 v[138:139], v[138:139], v[30:31] op_sel_hi:[1,0]
    v_pk_mul_f32 v[140:141], v[140:141], v[30:31] op_sel_hi:[1,0]
    v_pk_mul_f32 v[142:143], v[142:143], v[30:31] op_sel_hi:[1,0]
    v_cvt_pk_bf16_f32 v64, v128, v129
    v_cvt_pk_bf16_f32 v65, v130, v131
    v_cvt_pk_bf16_f32 v66, v132, v133
    v_cvt_pk_bf16_f32 v67, v134, v135
    v_cvt_pk_bf16_f32 v68, v136, v137
    v_cvt_pk_bf16_f32 v69, v138, v139
    v_cvt_pk_bf16_f32 v70, v140, v141
    v_cvt_pk_bf16_f32 v71, v142, v143
    v_permlane32_swap_b32 v64, v66
    v_permlane32_swap_b32 v65, v67
    v_permlane32_swap_b32 v68, v70
    v_permlane32_swap_b32 v69, v71
    v_permlane16_swap_b32 v64, v66
    v_permlane16_swap_b32 v65, v67
    v_permlane16_swap_b32 v68, v70
    v_permlane16_swap_b32 v69, v71
    buffer_store_dwordx4 v[64:67], v5, s[32:35], s66 offen offset:0
    buffer_store_dwordx4 v[68:71], v5, s[32:35], s66 offen offset:1024
    v_pk_mul_f32 v[144:145], v[144:145], v[30:31] op_sel_hi:[1,0]
    v_pk_mul_f32 v[146:147], v[146:147], v[30:31] op_sel_hi:[1,0]
    v_pk_mul_f32 v[148:149], v[148:149], v[30:31] op_sel_hi:[1,0]
    v_pk_mul_f32 v[150:151], v[150:151], v[30:31] op_sel_hi:[1,0]
    v_pk_mul_f32 v[152:153], v[152:153], v[30:31] op_sel_hi:[1,0]
    v_pk_mul_f32 v[154:155], v[154:155], v[30:31] op_sel_hi:[1,0]
    v_pk_mul_f32 v[156:157], v[156:157], v[30:31] op_sel_hi:[1,0]
    v_pk_mul_f32 v[158:159], v[158:159], v[30:31] op_sel_hi:[1,0]
    v_cvt_pk_bf16_f32 v72, v144, v145
    v_cvt_pk_bf16_f32 v73, v146, v147
    v_cvt_pk_bf16_f32 v74, v148, v149
    v_cvt_pk_bf16_f32 v75, v150, v151
    v_cvt_pk_bf16_f32 v76, v152, v153
    v_cvt_pk_bf16_f32 v77, v154, v155
    v_cvt_pk_bf16_f32 v78, v156, v157
    v_cvt_pk_bf16_f32 v79, v158, v159
    v_permlane32_swap_b32 v72, v74
    v_permlane32_swap_b32 v73, v75
    v_permlane32_swap_b32 v76, v78
    v_permlane32_swap_b32 v77, v79
    v_permlane16_swap_b32 v72, v74
    v_permlane16_swap_b32 v73, v75
    v_permlane16_swap_b32 v76, v78
    v_permlane16_swap_b32 v77, v79
    buffer_store_dwordx4 v[72:75], v5, s[32:35], s66 offen offset:2048
    buffer_store_dwordx4 v[76:79], v5, s[32:35], s66 offen offset:3072
    v_add3_u32 v24, v64, v65, s52
    v_add3_u32 v24, v24, v66, v67
    v_add3_u32 v24, v24, v68, v69
    v_add3_u32 v24, v24, v70, v71
    v_add3_u32 v24, v24, v72, v73
    v_add3_u32 v24, v24, v74, v75
    v_add3_u32 v24, v24, v76, v77
    v_add3_u32 v24, v24, v78, v79
    buffer_store_dword v24, v23, s[32:35], s44 offen
    s_cmp_lg_u32 s30, 0
    s_cbranch_scc1 Ls_22
Lb_23:
    s_waitcnt vmcnt(0)
    s_cmp_lg_u32 s30, 0
    s_cbranch_scc1 Ls_24
Lb_25:
    buffer_load_dwordx4 v[80:83], v5, s[32:35], s67 offen offset:0 sc1
    buffer_load_dwordx4 v[84:87], v5, s[32:35], s67 offen offset:1024 sc1
    buffer_load_dwordx4 v[88:91], v5, s[32:35], s67 offen offset:2048 sc1
    buffer_load_dwordx4 v[92:95], v5, s[32:35], s67 offen offset:3072 sc1
    buffer_load_dword v25, v23, s[32:35], s45 offen sc1
    s_cmp_lg_u32 s30, 0
    s_cbranch_scc1 Ls_26
Lb_27:
    buffer_load_dwordx4 v[96:99], v5, s[32:35], s68 offen offset:0 sc1
    buffer_load_dwordx4 v[100:103], v5, s[32:35], s68 offen offset:1024 sc1
    buffer_load_dwordx4 v[104:107], v5, s[32:35], s68 offen offset:2048 sc1
    buffer_load_dwordx4 v[108:111], v5, s[32:35], s68 offen offset:3072 sc1
    buffer_load_dword v26, v23, s[32:35], s46 offen sc1
    s_cmp_lg_u32 s30, 0
    s_cbranch_scc1 Ls_28
Lb_29:
    buffer_load_dwordx4 v[112:115], v5, s[32:35], s69 offen offset:0 sc1
    buffer_load_dwordx4 v[116:119], v5, s[32:35], s69 offen offset:1024 sc1
    buffer_load_dwordx4 v[120:123], v5, s[32:35], s69 offen offset:2048 sc1
    buffer_load_dwordx4 v[124:127], v5, s[32:35], s69 offen offset:3072 sc1
    buffer_load_dword v27, v23, s[32:35], s47 offen sc1
    v_cmp_gt_u32 vcc, 1, v4
    s_cbranch_vccnz Ls_30
Lb_31:
    ds_read_b128 v[32:35], v10 offset:0
    ds_read_b128 v[36:39], v10 offset:8192
    ds_read_b128 v[40:43], v11 offset:0
    ds_read_b128 v[44:47], v11 offset:8192
    ds_read_b128 v[48:51], v12 offset:0
    ds_read_b128 v[52:55], v12 offset:8192
    s_waitcnt lgkmcnt(5)
    v_mfma_f32_16x16x32_bf16 v[192:195], v[32:35], v[64:67], 0
    ds_read_b128 v[56:59], v13 offset:0
    v_mfma_f32_16x16x32_bf16 v[200:203], v[32:35], v[68:71], 0
    s_waitcnt lgkmcnt(4)
    v_mfma_f32_16x16x32_bf16 v[196:199], v[36:39], v[64:67], 0
    ds_read_b128 v[60:63], v13 offset:8192
    v_mfma_f32_16x16x32_bf16 v[204:207], v[36:39], v[68:71], 0
    v_mfma_f32_16x16x32_bf16 v[192:195], v[40:43], v[72:75], v[192:195]
    ds_read_b32 v4, v1 offset:1024
    ds_read_b128 v[32:35], v10 offset:256
    v_mfma_f32_16x16x32_bf16 v[200:203], v[40:43], v[76:79], v[200:203]
    s_waitcnt lgkmcnt(5)
    v_mfma_f32_16x16x32_bf16 v[196:199], v[44:47], v[72:75], v[196:199]
    ds_read_b128 v[36:39], v10 offset:8448
    v_mfma_f32_16x16x32_bf16 v[204:207], v[44:47], v[76:79], v[204:207]
    s_waitcnt vmcnt(10)
    v_add3_u32 v29, v80, v81, s52
    v_add3_u32 v29, v29, v82, v83
    v_add3_u32 v29, v29, v84, v85
    v_add3_u32 v29, v29, v86, v87
    v_add3_u32 v29, v29, v88, v89
    v_add3_u32 v29, v29, v90, v91
    v_add3_u32 v29, v29, v92, v93
    v_add3_u32 v29, v29, v94, v95
    v_cmp_ne_u32 vcc, v29, v25
    s_cbranch_vccnz Ls_32
Lb_33:
    v_mfma_f32_16x16x32_bf16 v[192:195], v[48:51], v[80:83], v[192:195]
    ds_read_b128 v[40:43], v11 offset:256
    v_mfma_f32_16x16x32_bf16 v[200:203], v[48:51], v[84:87], v[200:203]
    s_waitcnt lgkmcnt(5)
    v_mfma_f32_16x16x32_bf16 v[196:199], v[52:55], v[80:83], v[196:199]
    ds_read_b128 v[44:47], v11 offset:8448
    v_mfma_f32_16x16x32_bf16 v[204:207], v[52:55], v[84:87], v[204:207]
    v_mfma_f32_16x16x32_bf16 v[192:195], v[56:59], v[88:91], v[192:195]
    ds_read_b128 v[48:51], v12 offset:256
    v_mfma_f32_16x16x32_bf16 v[200:203], v[56:59], v[92:95], v[200:203]
    s_waitcnt lgkmcnt(4)
    v_mfma_f32_16x16x32_bf16 v[196:199], v[60:63], v[88:91], v[196:199]
    ds_read_b128 v[52:55], v12 offset:8448
    v_mfma_f32_16x16x32_bf16 v[204:207], v[60:63], v[92:95], v[204:207]
    s_waitcnt vmcnt(5)
    v_add3_u32 v29, v96, v97, s52
    v_add3_u32 v29, v29, v98, v99
    v_add3_u32 v29, v29, v100, v101
    v_add3_u32 v29, v29, v102, v103
    v_add3_u32 v29, v29, v104, v105
    v_add3_u32 v29, v29, v106, v107
    v_add3_u32 v29, v29, v108, v109
    v_add3_u32 v29, v29, v110, v111
    v_cmp_ne_u32 vcc, v29, v26
    s_cbranch_vccnz Ls_36
Lb_37:
    v_mfma_f32_16x16x32_bf16 v[192:195], v[32:35], v[96:99], v[192:195]
    ds_read_b128 v[56:59], v13 offset:256
    v_mfma_f32_16x16x32_bf16 v[200:203], v[32:35], v[100:103], v[200:203]
    s_waitcnt lgkmcnt(4)
    v_mfma_f32_16x16x32_bf16 v[196:199], v[36:39], v[96:99], v[196:199]
    ds_read_b128 v[60:63], v13 offset:8448
    v_mfma_f32_16x16x32_bf16 v[204:207], v[36:39], v[100:103], v[204:207]
    v_cmp_gt_u32 vcc, 2, v4
    s_cbranch_vccnz Ls_40
Lb_41:
    v_mfma_f32_16x16x32_bf16 v[192:195], v[40:43], v[104:107], v[192:195]
    ds_read_b128 v[32:35], v10 offset:16384
    v_mfma_f32_16x16x32_bf16 v[200:203], v[40:43], v[108:111], v[200:203]
    s_waitcnt lgkmcnt(4)
    v_mfma_f32_16x16x32_bf16 v[196:199], v[44:47], v[104:107], v[196:199]
    ds_read_b128 v[36:39], v10 offset:24576
    v_mfma_f32_16x16x32_bf16 v[204:207], v[44:47], v[108:111], v[204:207]
    s_waitcnt vmcnt(0)
    v_add3_u32 v29, v112, v113, s52
    v_add3_u32 v29, v29, v114, v115
    v_add3_u32 v29, v29, v116, v117
    v_add3_u32 v29, v29, v118, v119
    v_add3_u32 v29, v29, v120, v121
    v_add3_u32 v29, v29, v122, v123
    v_add3_u32 v29, v29, v124, v125
    v_add3_u32 v29, v29, v126, v127
    v_cmp_ne_u32 vcc, v29, v27
    s_cbranch_vccnz Ls_42
Lb_43:
    s_or_b32 s60, s29, 3
    v_mov_b32 v30, s26
    v_mov_b32 v31, s60
    s_mov_b64 exec, 1
    buffer_store_dwordx2 v[30:31], off, s[32:35], s44 offset:640
    s_mov_b64 exec, -1
    s_cmp_lg_u32 s30, 0
    s_cbranch_scc1 Ls_46
Lb_47:
    v_mfma_f32_16x16x32_bf16 v[192:195], v[48:51], v[112:115], v[192:195]
    ds_read_b128 v[40:43], v11 offset:16384
    v_mov_b32 v24, 0x3f803f80
    v_mfma_f32_16x16x32_bf16 v[200:203], v[48:51], v[116:119], v[200:203]
    s_waitcnt lgkmcnt(4)
    v_mov_b32 v25, 0x3f803f80
    v_mov_b32 v26, 0x3f803f80
    v_mov_b32 v27, 0x3f803f80
    v_mfma_f32_16x16x32_bf16 v[196:199], v[52:55], v[112:115], v[196:199]
    ds_read_b128 v[44:47], v11 offset:24576
    v_mfma_f32_16x16x32_bf16 v[204:207], v[52:55], v[116:119], v[204:207]
    v_mfma_f32_16x16x32_bf16 v[192:195], v[56:59], v[120:123], v[192:195]
    ds_read_b128 v[48:51], v12 offset:16384
    v_mfma_f32_16x16x32_bf16 v[200:203], v[56:59], v[124:127], v[200:203]
    s_waitcnt lgkmcnt(4)
    v_mfma_f32_16x16x32_bf16 v[196:199], v[60:63], v[120:123], v[196:199]
    ds_read_b128 v[52:55], v12 offset:24576
    v_mfma_f32_16x16x32_bf16 v[204:207], v[60:63], v[124:127], v[204:207]
    v_mfma_f32_16x16x32_bf16 v[208:211], v[32:35], v[64:67], 0
    ds_read_b128 v[56:59], v13 offset:16384
    v_mfma_f32_16x16x32_bf16 v[216:219], v[32:35], v[68:71], 0
    s_waitcnt lgkmcnt(4)
    v_mfma_f32_16x16x32_bf16 v[212:215], v[36:39], v[64:67], 0
    ds_read_b128 v[60:63], v13 offset:24576
    v_mfma_f32_16x16x32_bf16 v[220:223], v[36:39], v[68:71], 0
    v_mfma_f32_16x16x32_bf16 v[208:211], v[40:43], v[72:75], v[208:211]
    ds_read_b32 v4, v1 offset:1024
    ds_read_b128 v[32:35], v10 offset:16640
    v_mfma_f32_16x16x32_bf16 v[216:219], v[40:43], v[76:79], v[216:219]
    s_waitcnt lgkmcnt(5)
    v_mfma_f32_16x16x32_bf16 v[212:215], v[44:47], v[72:75], v[212:215]
    ds_read_b128 v[36:39], v10 offset:24832
    v_max_f32 v20, v192, v193
    v_mfma_f32_16x16x32_bf16 v[220:223], v[44:47], v[76:79], v[220:223]
    v_max3_f32 v20, v20, v194, v195
    v_max3_f32 v20, v20, v196, v197
    v_max3_f32 v20, v20, v198, v199
    v_mfma_f32_16x16x32_bf16 v[208:211], v[48:51], v[80:83], v[208:211]
    ds_read_b128 v[40:43], v11 offset:16640
    v_max_f32 v21, v200, v201
    v_mfma_f32_16x16x32_bf16 v[216:219], v[48:51], v[84:87], v[216:219]
    s_waitcnt lgkmcnt(5)
    v_max3_f32 v21, v21, v202, v203
    v_max3_f32 v21, v21, v204, v205
    v_max3_f32 v21, v21, v206, v207
    v_mfma_f32_16x16x32_bf16 v[212:215], v[52:55], v[80:83], v[212:215]
    ds_read_b128 v[44:47], v11 offset:24832
    v_mfma_f32_16x16x32_bf16 v[220:223], v[52:55], v[84:87], v[220:223]
    s_nop 1
    v_permlane32_swap_b32 v20, v21
    s_nop 1
    v_max_f32 v20, v20, v21
    v_mov_b32 v21, v20
    v_mfma_f32_16x16x32_bf16 v[208:211], v[56:59], v[88:91], v[208:211]
    ds_read_b128 v[48:51], v12 offset:16640
    v_mfma_f32_16x16x32_bf16 v[216:219], v[56:59], v[92:95], v[216:219]
    s_waitcnt lgkmcnt(4)
    s_nop 1
    v_permlane16_swap_b32 v20, v21
    s_nop 1
    v_max_f32 v20, v20, v21
    v_mfma_f32_16x16x32_bf16 v[212:215], v[60:63], v[88:91], v[212:215]
    ds_read_b128 v[52:55], v12 offset:24832
    v_mov_b32 v22, v20
    v_mfma_f32_16x16x32_bf16 v[220:223], v[60:63], v[92:95], v[220:223]
    v_mov_b32 v21, v20
    s_nop 1
    v_permlane32_swap_b32 v20, v21
    v_mfma_f32_16x16x32_bf16 v[208:211], v[32:35], v[96:99], v[208:211]
    ds_read_b128 v[56:59], v13 offset:16640
    v_mfma_f32_16x16x32_bf16 v[216:219], v[32:35], v[100:103], v[216:219]
    s_waitcnt lgkmcnt(4)
    s_nop 1
    v_sub_f32 v240, 0, v20
    v_sub_f32 v241, 0, v20
    v_sub_f32 v242, 0, v20
    v_sub_f32 v243, 0, v20
    v_mfma_f32_16x16x32_bf16 v[212:215], v[36:39], v[96:99], v[212:215]
    ds_read_b128 v[60:63], v13 offset:24832
    v_sub_f32 v244, 0, v21
    v_mfma_f32_16x16x32_bf16 v[220:223], v[36:39], v[100:103], v[220:223]
    v_cmp_gt_u32 vcc, 3, v4
    v_sub_f32 v245, 0, v21
    v_sub_f32 v246, 0, v21
    v_sub_f32 v247, 0, v21
    s_cbranch_vccnz Ls_48
Lb_49:
    v_mfma_f32_16x16x32_bf16 v[208:211], v[40:43], v[104:107], v[208:211]
    ds_read_b128 v[32:35], v10 offset:32768
    v_add_f32 v192, v192, v240
    v_mfma_f32_16x16x32_bf16 v[216:219], v[40:43], v[108:111], v[216:219]
    s_waitcnt lgkmcnt(4)
    v_add_f32 v193, v193, v240
    v_add_f32 v194, v194, v240
    v_add_f32 v195, v195, v240
    v_add_f32 v196, v196, v240
    v_mfma_f32_16x16x32_bf16 v[212:215], v[44:47], v[104:107], v[212:215]
    ds_read_b128 v[36:39], v10 offset:40960
    v_add_f32 v197, v197, v240
    v_mfma_f32_16x16x32_bf16 v[220:223], v[44:47], v[108:111], v[220:223]
    v_add_f32 v198, v198, v240
    v_add_f32 v199, v199, v240
    v_add_f32 v200, v200, v244
    v_mfma_f32_16x16x32_bf16 v[208:211], v[48:51], v[112:115], v[208:211]
    ds_read_b128 v[40:43], v11 offset:32768
    v_add_f32 v201, v201, v244
    v_mfma_f32_16x16x32_bf16 v[216:219], v[48:51], v[116:119], v[216:219]
    s_waitcnt lgkmcnt(4)
    v_add_f32 v202, v202, v244
    v_add_f32 v203, v203, v244
    v_add_f32 v204, v204, v244
    v_mfma_f32_16x16x32_bf16 v[212:215], v[52:55], v[112:115], v[212:215]
    ds_read_b128 v[44:47], v11 offset:40960
    v_add_f32 v205, v205, v244
    v_mfma_f32_16x16x32_bf16 v[220:223], v[52:55], v[116:119], v[220:223]
    v_add_f32 v206, v206, v244
    v_add_f32 v207, v207, v244
    v_exp_f32 v192, v192
    v_exp_f32 v193, v193
    v_mfma_f32_16x16x32_bf16 v[208:211], v[56:59], v[120:123], v[208:211]
    ds_read_b128 v[48:51], v12 offset:32768
    v_mfma_f32_16x16x32_bf16 v[216:219], v[56:59], v[124:127], v[216:219]
    s_waitcnt lgkmcnt(4)
    v_exp_f32 v194, v194
    v_exp_f32 v195, v195
    v_cvt_pk_bf16_f32 v128, v192, v193
    v_exp_f32 v196, v196
    v_mfma_f32_16x16x32_bf16 v[212:215], v[60:63], v[120:123], v[212:215]
    ds_read_b128 v[52:55], v12 offset:40960
    v_mfma_f32_16x16x32_bf16 v[220:223], v[60:63], v[124:127], v[220:223]
    s_add_u32 m0, s0, 4060
    s_nop 0
    global_load_lds_dword v7, s[16:17] offset:36
    v_exp_f32 v197, v197
    v_cvt_pk_bf16_f32 v129, v194, v195
    v_exp_f32 v198, v198
    v_exp_f32 v199, v199
    v_mfma_f32_16x16x32_bf16 v[224:227], v[32:35], v[64:67], v[240:243]
    ds_read_b128 v[56:59], v13 offset:32768
    v_cvt_pk_bf16_f32 v130, v196, v197
    v_mfma_f32_16x16x32_bf16 v[232:235], v[32:35], v[68:71], v[244:247]
    s_waitcnt lgkmcnt(4)
    v_exp_f32 v200, v200
    v_exp_f32 v201, v201
    v_cvt_pk_bf16_f32 v131, v198, v199
    v_exp_f32 v202, v202
    v_mfma_f32_16x16x32_bf16 v[228:231], v[36:39], v[64:67], v[240:243]
    ds_read_b128 v[60:63], v13 offset:40960
    v_mfma_f32_16x16x32_bf16 v[236:239], v[36:39], v[68:71], v[244:247]
    v_exp_f32 v203, v203
    v_cvt_pk_bf16_f32 v132, v200, v201
    v_exp_f32 v204, v204
    v_exp_f32 v205, v205
    v_mfma_f32_16x16x32_bf16 v[224:227], v[40:43], v[72:75], v[224:227]
    ds_read_b32 v4, v1 offset:1024
    ds_read_b128 v[32:35], v10 offset:33024
    v_cvt_pk_bf16_f32 v133, v202, v203
    v_mfma_f32_16x16x32_bf16 v[232:235], v[40:43], v[76:79], v[232:235]
    s_waitcnt lgkmcnt(5)
    v_exp_f32 v206, v206
    v_exp_f32 v207, v207
    v_cvt_pk_bf16_f32 v134, v204, v205
    v_cvt_pk_bf16_f32 v135, v206, v207
    v_mfma_f32_16x16x32_bf16 v[228:231], v[44:47], v[72:75], v[228:231]
    ds_read_b128 v[36:39], v10 offset:41216
    v_add_f32 v208, v208, v240
    v_mfma_f32_16x16x32_bf16 v[236:239], v[44:47], v[76:79], v[236:239]
    v_add_f32 v209, v209, v240
    v_add_f32 v210, v210, v240
    v_mfma_f32_16x16x32_bf16 v[224:227], v[48:51], v[80:83], v[224:227]
    ds_read_b128 v[40:43], v11 offset:33024
    v_add_f32 v211, v211, v240
    v_mfma_f32_16x16x32_bf16 v[232:235], v[48:51], v[84:87], v[232:235]
    s_waitcnt lgkmcnt(5)
    v_add_f32 v212, v212, v240
    v_add_f32 v213, v213, v240
    v_mfma_f32_16x16x32_bf16 v[228:231], v[52:55], v[80:83], v[228:231]
    ds_read_b128 v[44:47], v11 offset:41216
    v_add_f32 v214, v214, v240
    v_mfma_f32_16x16x32_bf16 v[236:239], v[52:55], v[84:87], v[236:239]
    v_add_f32 v215, v215, v240
    v_add_f32 v216, v216, v244
    v_mfma_f32_16x16x32_bf16 v[224:227], v[56:59], v[88:91], v[224:227]
    ds_read_b128 v[48:51], v12 offset:33024
    v_add_f32 v217, v217, v244
    v_mfma_f32_16x16x32_bf16 v[232:235], v[56:59], v[92:95], v[232:235]
    s_waitcnt lgkmcnt(4)
    v_add_f32 v218, v218, v244
    v_add_f32 v219, v219, v244
    v_mfma_f32_16x16x32_bf16 v[228:231], v[60:63], v[88:91], v[228:231]
    ds_read_b128 v[52:55], v12 offset:41216
    v_add_f32 v220, v220, v244
    v_mfma_f32_16x16x32_bf16 v[236:239], v[60:63], v[92:95], v[236:239]
    v_add_f32 v221, v221, v244
    v_add_f32 v222, v222, v244
    v_mfma_f32_16x16x32_bf16 v[224:227], v[32:35], v[96:99], v[224:227]
    ds_read_b128 v[56:59], v13 offset:33024
    v_add_f32 v223, v223, v244
    v_mfma_f32_16x16x32_bf16 v[232:235], v[32:35], v[100:103], v[232:235]
    s_waitcnt lgkmcnt(4)
    v_max3_f32 v20, v208, v209, v210
    v_max3_f32 v20, v20, v211, v212
    v_mfma_f32_16x16x32_bf16 v[248:251], v[24:27], v[128:131], 0
    v_mfma_f32_16x16x32_bf16 v[228:231], v[36:39], v[96:99], v[228:231]
    ds_read_b128 v[60:63], v13 offset:41216
    v_max3_f32 v20, v20, v213, v214
    v_mfma_f32_16x16x32_bf16 v[236:239], v[36:39], v[100:103], v[236:239]
    v_cmp_gt_u32 vcc, 4, v4
    v_max3_f32 v20, v20, v215, v216
    v_max3_f32 v20, v20, v217, v218
    s_cbranch_vccnz Ls_50
Lb_51:
    v_mfma_f32_16x16x32_bf16 v[224:227], v[40:43], v[104:107], v[224:227]
    ds_read_b128 v[32:35], v10 offset:49152
    v_mfma_f32_16x16x32_bf16 v[232:235], v[40:43], v[108:111], v[232:235]
    s_waitcnt lgkmcnt(4)
    v_mfma_f32_16x16x32_bf16 v[252:255], v[24:27], v[132:135], 0
    v_max3_f32 v20, v20, v219, v220
    v_max3_f32 v20, v20, v221, v222
    v_mfma_f32_16x16x32_bf16 v[228:231], v[44:47], v[104:107], v[228:231]
    ds_read_b128 v[36:39], v10 offset:57344
    v_max_f32 v20, v20, v223
    v_mfma_f32_16x16x32_bf16 v[236:239], v[44:47], v[108:111], v[236:239]
    v_cmp_lt_f32 vcc, s40, v20
    s_cbranch_vccnz Ls_52
Lb_53:
    v_exp_f32 v208, v208
    v_mfma_f32_16x16x32_bf16 v[224:227], v[48:51], v[112:115], v[224:227]
    ds_read_b128 v[40:43], v11 offset:49152
    v_mfma_f32_16x16x32_bf16 v[232:235], v[48:51], v[116:119], v[232:235]
    s_waitcnt lgkmcnt(4)
    v_exp_f32 v209, v209
    v_exp_f32 v210, v210
    v_exp_f32 v211, v211
    v_mfma_f32_16x16x32_bf16 v[228:231], v[52:55], v[112:115], v[228:231]
    ds_read_b128 v[44:47], v11 offset:57344
    v_cvt_pk_bf16_f32 v136, v208, v209
    v_mfma_f32_16x16x32_bf16 v[236:239], v[52:55], v[116:119], v[236:239]
    v_exp_f32 v212, v212
    v_exp_f32 v213, v213
    v_cvt_pk_bf16_f32 v137, v210, v211
    v_mfma_f32_16x16x32_bf16 v[224:227], v[56:59], v[120:123], v[224:227]
    ds_read_b128 v[48:51], v12 offset:49152
    v_mfma_f32_16x16x32_bf16 v[232:235], v[56:59], v[124:127], v[232:235]
    s_waitcnt lgkmcnt(4)
    v_exp_f32 v214, v214
    v_exp_f32 v215, v215
    v_cvt_pk_bf16_f32 v138, v212, v213
    v_mfma_f32_16x16x32_bf16 v[228:231], v[60:63], v[120:123], v[228:231]
    ds_read_b128 v[52:55], v12 offset:57344
    v_mfma_f32_16x16x32_bf16 v[236:239], v[60:63], v[124:127], v[236:239]
    v_exp_f32 v216, v216
    v_exp_f32 v217, v217
    v_cvt_pk_bf16_f32 v139, v214, v215
    v_mfma_f32_16x16x32_bf16 v[192:195], v[32:35], v[64:67], v[240:243]
    ds_read_b128 v[56:59], v13 offset:49152
    v_mfma_f32_16x16x32_bf16 v[200:203], v[32:35], v[68:71], v[244:247]
    s_waitcnt lgkmcnt(4)
    v_exp_f32 v218, v218
    v_exp_f32 v219, v219
    v_cvt_pk_bf16_f32 v140, v216, v217
    v_mfma_f32_16x16x32_bf16 v[196:199], v[36:39], v[64:67], v[240:243]
    ds_read_b128 v[60:63], v13 offset:57344
    v_mfma_f32_16x16x32_bf16 v[204:207], v[36:39], v[68:71], v[244:247]
    v_exp_f32 v220, v220
    v_exp_f32 v221, v221
    v_cvt_pk_bf16_f32 v141, v218, v219
    v_mfma_f32_16x16x32_bf16 v[192:195], v[40:43], v[72:75], v[192:195]
    ds_read_b32 v4, v1 offset:1024
    ds_read_b128 v[32:35], v10 offset:49408
    v_mfma_f32_16x16x32_bf16 v[200:203], v[40:43], v[76:79], v[200:203]
    s_waitcnt lgkmcnt(5)
    v_exp_f32 v222, v222
    v_exp_f32 v223, v223
    v_cvt_pk_bf16_f32 v142, v220, v221
    v_cvt_pk_bf16_f32 v143, v222, v223
    v_mfma_f32_16x16x32_bf16 v[196:199], v[44:47], v[72:75], v[196:199]
    ds_read_b128 v[36:39], v10 offset:57600
    v_max3_f32 v20, v224, v225, v226
    v_mfma_f32_16x16x32_bf16 v[204:207], v[44:47], v[76:79], v[204:207]
    v_max3_f32 v20, v20, v227, v228
    v_add_u32 v10, 0x10000, v10
    v_mfma_f32_16x16x32_bf16 v[192:195], v[48:51], v[80:83], v[192:195]
    ds_read_b128 v[40:43], v11 offset:49408
    v_mfma_f32_16x16x32_bf16 v[200:203], v[48:51], v[84:87], v[200:203]
    s_waitcnt lgkmcnt(5)
    v_mfma_f32_16x16x32_bf16 v[248:251], v[24:27], v[136:139], v[248:251]
    v_max3_f32 v20, v20, v229, v230
    v_mfma_f32_16x16x32_bf16 v[196:199], v[52:55], v[80:83], v[196:199]
    ds_read_b128 v[44:47], v11 offset:57600
    v_max3_f32 v20, v20, v231, v232
    v_mfma_f32_16x16x32_bf16 v[204:207], v[52:55], v[84:87], v[204:207]
    v_max3_f32 v20, v20, v233, v234
    v_add_u32 v11, 0x10000, v11
    v_mfma_f32_16x16x32_bf16 v[192:195], v[56:59], v[88:91], v[192:195]
    ds_read_b128 v[48:51], v12 offset:49408
    v_mfma_f32_16x16x32_bf16 v[200:203], v[56:59], v[92:95], v[200:203]
    s_waitcnt lgkmcnt(4)
    v_mfma_f32_16x16x32_bf16 v[252:255], v[24:27], v[140:143], v[252:255]
    v_max3_f32 v20, v20, v235, v236
    v_mfma_f32_16x16x32_bf16 v[196:199], v[60:63], v[88:91], v[196:199]
    ds_read_b128 v[52:55], v12 offset:57600
    v_max3_f32 v20, v20, v237, v238
    v_mfma_f32_16x16x32_bf16 v[204:207], v[60:63], v[92:95], v[204:207]
    v_max_f32 v20, v20, v239
    v_add_u32 v12, 0x10000, v12
    v_mfma_f32_16x16x32_bf16 v[192:195], v[32:35], v[96:99], v[192:195]
    ds_read_b128 v[56:59], v13 offset:49408
    v_mfma_f32_16x16x32_bf16 v[200:203], v[32:35], v[100:103], v[200:203]
    s_waitcnt lgkmcnt(4)
    v_cmp_lt_f32 vcc, s40, v20
    s_cbranch_vccnz Ls_54
Lb_55:
    v_exp_f32 v224, v224
    v_exp_f32 v225, v225
    v_mfma_f32_16x16x32_bf16 v[196:199], v[36:39], v[96:99], v[196:199]
    ds_read_b128 v[60:63], v13 offset:57600
    v_mfma_f32_16x16x32_bf16 v[204:207], v[36:39], v[100:103], v[204:207]
    v_cmp_gt_u32 vcc, 5, v4
    v_exp_f32 v226, v226
    v_exp_f32 v227, v227
    v_add_u32 v13, 0x10000, v13
    s_cbranch_vccnz Ls_56
Lb_57:
    v_mfma_f32_16x16x32_bf16 v[192:195], v[40:43], v[104:107], v[192:195]
    ds_read_b128 v[32:35], v10 offset:0
    v_cvt_pk_bf16_f32 v144, v224, v225
    v_mfma_f32_16x16x32_bf16 v[200:203], v[40:43], v[108:111], v[200:203]
    s_waitcnt lgkmcnt(4)
    v_exp_f32 v228, v228
    v_mfma_f32_16x16x32_bf16 v[196:199], v[44:47], v[104:107], v[196:199]
    ds_read_b128 v[36:39], v10 offset:8192
    v_mfma_f32_16x16x32_bf16 v[204:207], v[44:47], v[108:111], v[204:207]
    v_exp_f32 v229, v229
    v_cvt_pk_bf16_f32 v145, v226, v227
    v_mfma_f32_16x16x32_bf16 v[192:195], v[48:51], v[112:115], v[192:195]
    ds_read_b128 v[40:43], v11 offset:0
    v_mfma_f32_16x16x32_bf16 v[200:203], v[48:51], v[116:119], v[200:203]
    s_waitcnt lgkmcnt(4)
    v_exp_f32 v230, v230
    v_exp_f32 v231, v231
    v_mfma_f32_16x16x32_bf16 v[196:199], v[52:55], v[112:115], v[196:199]
    ds_read_b128 v[44:47], v11 offset:8192
    v_cvt_pk_bf16_f32 v146, v228, v229
    v_mfma_f32_16x16x32_bf16 v[204:207], v[52:55], v[116:119], v[204:207]
    v_exp_f32 v232, v232
    v_exp_f32 v233, v233
    v_mfma_f32_16x16x32_bf16 v[192:195], v[56:59], v[120:123], v[192:195]
    ds_read_b128 v[48:51], v12 offset:0
    v_cvt_pk_bf16_f32 v147, v230, v231
    v_mfma_f32_16x16x32_bf16 v[200:203], v[56:59], v[124:127], v[200:203]
    s_waitcnt lgkmcnt(4)
    v_exp_f32 v234, v234
    v_mfma_f32_16x16x32_bf16 v[196:199], v[60:63], v[120:123], v[196:199]
    ds_read_b128 v[52:55], v12 offset:8192
    v_mfma_f32_16x16x32_bf16 v[204:207], v[60:63], v[124:127], v[204:207]
    s_add_u32 m0, s0, 4052
    s_nop 0
    global_load_lds_dword v7, s[16:17] offset:44
    v_exp_f32 v235, v235
    v_cvt_pk_bf16_f32 v148, v232, v233
    v_mfma_f32_16x16x32_bf16 v[208:211], v[32:35], v[64:67], v[240:243]
    ds_read_b128 v[56:59], v13 offset:0
    v_mfma_f32_16x16x32_bf16 v[216:219], v[32:35], v[68:71], v[244:247]
    s_waitcnt lgkmcnt(4)
    v_exp_f32 v236, v236
    v_exp_f32 v237, v237
    v_mfma_f32_16x16x32_bf16 v[212:215], v[36:39], v[64:67], v[240:243]
    ds_read_b128 v[60:63], v13 offset:8192
    v_cvt_pk_bf16_f32 v149, v234, v235
    v_mfma_f32_16x16x32_bf16 v[220:223], v[36:39], v[68:71], v[244:247]
    v_exp_f32 v238, v238
    v_mfma_f32_16x16x32_bf16 v[208:211], v[40:43], v[72:75], v[208:211]
    ds_read_b32 v4, v1 offset:1024
    ds_read_b128 v[32:35], v10 offset:256
    v_mfma_f32_16x16x32_bf16 v[216:219], v[40:43], v[76:79], v[216:219]
    s_waitcnt lgkmcnt(5)
    v_exp_f32 v239, v239
    v_cvt_pk_bf16_f32 v150, v236, v237
    v_cvt_pk_bf16_f32 v151, v238, v239
    v_mfma_f32_16x16x32_bf16 v[212:215], v[44:47], v[72:75], v[212:215]
    ds_read_b128 v[36:39], v10 offset:8448
    v_max3_f32 v20, v192, v193, v194
    v_mfma_f32_16x16x32_bf16 v[220:223], v[44:47], v[76:79], v[220:223]
    v_max3_f32 v20, v20, v195, v196
    v_mfma_f32_16x16x32_bf16 v[208:211], v[48:51], v[80:83], v[208:211]
    ds_read_b128 v[40:43], v11 offset:256
    v_mfma_f32_16x16x32_bf16 v[216:219], v[48:51], v[84:87], v[216:219]
    s_waitcnt lgkmcnt(5)
    v_mfma_f32_16x16x32_bf16 v[248:251], v[24:27], v[144:147], v[248:251]
    v_max3_f32 v20, v20, v197, v198
    v_mfma_f32_16x16x32_bf16 v[212:215], v[52:55], v[80:83], v[212:215]
    ds_read_b128 v[44:47], v11 offset:8448
    v_max3_f32 v20, v20, v199, v200
    v_mfma_f32_16x16x32_bf16 v[220:223], v[52:55], v[84:87], v[220:223]
    v_max3_f32 v20, v20, v201, v202
    v_mfma_f32_16x16x32_bf16 v[208:211], v[56:59], v[88:91], v[208:211]
    ds_read_b128 v[48:51], v12 offset:256
    v_mfma_f32_16x16x32_bf16 v[216:219], v[56:59], v[92:95], v[216:219]
    s_waitcnt lgkmcnt(4)
    v_mfma_f32_16x16x32_bf16 v[252:255], v[24:27], v[148:151], v[252:255]
    v_max3_f32 v20, v20, v203, v204
    v_mfma_f32_16x16x32_bf16 v[212:215], v[60:63], v[88:91], v[212:215]
    ds_read_b128 v[52:55], v12 offset:8448
    v_max3_f32 v20, v20, v205, v206
    v_mfma_f32_16x16x32_bf16 v[220:223], v[60:63], v[92:95], v[220:223]
    v_max_f32 v20, v20, v207
    v_mfma_f32_16x16x32_bf16 v[208:211], v[32:35], v[96:99], v[208:211]
    ds_read_b128 v[56:59], v13 offset:256
    v_mfma_f32_16x16x32_bf16 v[216:219], v[32:35], v[100:103], v[216:219]
    s_waitcnt lgkmcnt(4)
    v_cmp_lt_f32 vcc, s40, v20
    s_cbranch_vccnz Ls_58
Lb_59:
    v_exp_f32 v192, v192
    v_exp_f32 v193, v193
    v_mfma_f32_16x16x32_bf16 v[212:215], v[36:39], v[96:99], v[212:215]
    ds_read_b128 v[60:63], v13 offset:8448
    v_mfma_f32_16x16x32_bf16 v[220:223], v[36:39], v[100:103], v[220:223]
    v_cmp_gt_u32 vcc, 6, v4
    v_exp_f32 v194, v194
    v_exp_f32 v195, v195
    s_cbranch_vccnz Ls_60
Lb_61:
    v_mfma_f32_16x16x32_bf16 v[208:211], v[40:43], v[104:107], v[208:211]
    ds_read_b128 v[32:35], v10 offset:16384
    v_cvt_pk_bf16_f32 v152, v192, v193
    v_mfma_f32_16x16x32_bf16 v[216:219], v[40:43], v[108:111], v[216:219]
    s_waitcnt lgkmcnt(4)
    v_exp_f32 v196, v196
    v_mfma_f32_16x16x32_bf16 v[212:215], v[44:47], v[104:107], v[212:215]
    ds_read_b128 v[36:39], v10 offset:24576
    v_mfma_f32_16x16x32_bf16 v[220:223], v[44:47], v[108:111], v[220:223]
    v_exp_f32 v197, v197
    v_cvt_pk_bf16_f32 v153, v194, v195
    v_mfma_f32_16x16x32_bf16 v[208:211], v[48:51], v[112:115], v[208:211]
    ds_read_b128 v[40:43], v11 offset:16384
    v_mfma_f32_16x16x32_bf16 v[216:219], v[48:51], v[116:119], v[216:219]
    s_waitcnt lgkmcnt(4)
    v_exp_f32 v198, v198
    v_exp_f32 v199, v199
    v_mfma_f32_16x16x32_bf16 v[212:215], v[52:55], v[112:115], v[212:215]
    ds_read_b128 v[44:47], v11 offset:24576
    v_cvt_pk_bf16_f32 v154, v196, v197
    v_mfma_f32_16x16x32_bf16 v[220:223], v[52:55], v[116:119], v[220:223]
    v_exp_f32 v200, v200
    v_exp_f32 v201, v201
    v_mfma_f32_16x16x32_bf16 v[208:211], v[56:59], v[120:123], v[208:211]
    ds_read_b128 v[48:51], v12 offset:16384
    v_cvt_pk_bf16_f32 v155, v198, v199
    v_mfma_f32_16x16x32_bf16 v[216:219], v[56:59], v[124:127], v[216:219]
    s_waitcnt lgkmcnt(4)
    v_exp_f32 v202, v202
    v_mfma_f32_16x16x32_bf16 v[212:215], v[60:63], v[120:123], v[212:215]
    ds_read_b128 v[52:55], v12 offset:24576
    v_mfma_f32_16x16x32_bf16 v[220:223], v[60:63], v[124:127], v[220:223]
    v_exp_f32 v203, v203
    v_cvt_pk_bf16_f32 v156, v200, v201
    v_mfma_f32_16x16x32_bf16 v[224:227], v[32:35], v[64:67], v[240:243]
    ds_read_b128 v[56:59], v13 offset:16384
    v_mfma_f32_16x16x32_bf16 v[232:235], v[32:35], v[68:71], v[244:247]
    s_waitcnt lgkmcnt(4)
    v_exp_f32 v204, v204
    v_exp_f32 v205, v205
    v_mfma_f32_16x16x32_bf16 v[228:231], v[36:39], v[64:67], v[240:243]
    ds_read_b128 v[60:63], v13 offset:24576
    v_cvt_pk_bf16_f32 v157, v202, v203
    v_mfma_f32_16x16x32_bf16 v[236:239], v[36:39], v[68:71], v[244:247]
    v_exp_f32 v206, v206
    v_mfma_f32_16x16x32_bf16 v[224:227], v[40:43], v[72:75], v[224:227]
    ds_read_b32 v4, v1 offset:1024
    ds_read_b128 v[32:35], v10 offset:16640
    v_mfma_f32_16x16x32_bf16 v[232:235], v[40:43], v[76:79], v[232:235]
    s_waitcnt lgkmcnt(5)
    v_exp_f32 v207, v207
    v_cvt_pk_bf16_f32 v158, v204, v205
    v_cvt_pk_bf16_f32 v159, v206, v207
    v_mfma_f32_16x16x32_bf16 v[228:231], v[44:47], v[72:75], v[228:231]
    ds_read_b128 v[36:39], v10 offset:24832
    v_max3_f32 v20, v208, v209, v210
    v_mfma_f32_16x16x32_bf16 v[236:239], v[44:47], v[76:79], v[236:239]
    v_max3_f32 v20, v20, v211, v212
    v_mfma_f32_16x16x32_bf16 v[224:227], v[48:51], v[80:83], v[224:227]
    ds_read_b128 v[40:43], v11 offset:16640
    v_mfma_f32_16x16x32_bf16 v[232:235], v[48:51], v[84:87], v[232:235]
    s_waitcnt lgkmcnt(5)
    v_mfma_f32_16x16x32_bf16 v[248:251], v[24:27], v[152:155], v[248:251]
    v_max3_f32 v20, v20, v213, v214
    v_mfma_f32_16x16x32_bf16 v[228:231], v[52:55], v[80:83], v[228:231]
    ds_read_b128 v[44:47], v11 offset:24832
    v_max3_f32 v20, v20, v215, v216
    v_mfma_f32_16x16x32_bf16 v[236:239], v[52:55], v[84:87], v[236:239]
    v_max3_f32 v20, v20, v217, v218
    v_mfma_f32_16x16x32_bf16 v[224:227], v[56:59], v[88:91], v[224:227]
    ds_read_b128 v[48:51], v12 offset:16640
    v_mfma_f32_16x16x32_bf16 v[232:235], v[56:59], v[92:95], v[232:235]
    s_waitcnt lgkmcnt(4)
    v_mfma_f32_16x16x32_bf16 v[252:255], v[24:27], v[156:159], v[252:255]
    v_max3_f32 v20, v20, v219, v220
    v_mfma_f32_16x16x32_bf16 v[228:231], v[60:63], v[88:91], v[228:231]
    ds_read_b128 v[52:55], v12 offset:24832
    v_max3_f32 v20, v20, v221, v222
    v_mfma_f32_16x16x32_bf16 v[236:239], v[60:63], v[92:95], v[236:239]
    v_max_f32 v20, v20, v223
    v_mfma_f32_16x16x32_bf16 v[224:227], v[32:35], v[96:99], v[224:227]
    ds_read_b128 v[56:59], v13 offset:16640
    v_mfma_f32_16x16x32_bf16 v[232:235], v[32:35], v[100:103], v[232:235]
    s_waitcnt lgkmcnt(4)
    v_cmp_lt_f32 vcc, s40, v20
    s_cbranch_vccnz Ls_62
Lb_63:
    v_exp_f32 v208, v208
    v_exp_f32 v209, v209
    v_mfma_f32_16x16x32_bf16 v[228:231], v[36:39], v[96:99], v[228:231]
    ds_read_b128 v[60:63], v13 offset:24832
    v_mfma_f32_16x16x32_bf16 v[236:239], v[36:39], v[100:103], v[236:239]
    v_cmp_gt_u32 vcc, 7, v4
    v_exp_f32 v210, v210
    v_exp_f32 v211, v211
    s_cbranch_vccnz Ls_64
Lb_65:
    v_mfma_f32_16x16x32_bf16 v[224:227], v[40:43], v[104:107], v[224:227]
    ds_read_b128 v[32:35], v10 offset:32768
    v_cvt_pk_bf16_f32 v160, v208, v209
    v_mfma_f32_16x16x32_bf16 v[232:235], v[40:43], v[108:111], v[232:235]
    s_waitcnt lgkmcnt(4)
    v_exp_f32 v212, v212
    v_mfma_f32_16x16x32_bf16 v[228:231], v[44:47], v[104:107], v[228:231]
    ds_read_b128 v[36:39], v10 offset:40960
    v_mfma_f32_16x16x32_bf16 v[236:239], v[44:47], v[108:111], v[236:239]
    v_exp_f32 v213, v213
    v_cvt_pk_bf16_f32 v161, v210, v211
    v_mfma_f32_16x16x32_bf16 v[224:227], v[48:51], v[112:115], v[224:227]
    ds_read_b128 v[40:43], v11 offset:32768
    v_mfma_f32_16x16x32_bf16 v[232:235], v[48:51], v[116:119], v[232:235]
    s_waitcnt lgkmcnt(4)
    v_exp_f32 v214, v214
    v_exp_f32 v215, v215
    v_mfma_f32_16x16x32_bf16 v[228:231], v[52:55], v[112:115], v[228:231]
    ds_read_b128 v[44:47], v11 offset:40960
    v_cvt_pk_bf16_f32 v162, v212, v213
    v_mfma_f32_16x16x32_bf16 v[236:239], v[52:55], v[116:119], v[236:239]
    v_exp_f32 v216, v216
    v_exp_f32 v217, v217
    v_mfma_f32_16x16x32_bf16 v[224:227], v[56:59], v[120:123], v[224:227]
    ds_read_b128 v[48:51], v12 offset:32768
    v_cvt_pk_bf16_f32 v163, v214, v215
    v_mfma_f32_16x16x32_bf16 v[232:235], v[56:59], v[124:127], v[232:235]
    s_waitcnt lgkmcnt(4)
    v_exp_f32 v218, v218
    v_mfma_f32_16x16x32_bf16 v[228:231], v[60:63], v[120:123], v[228:231]
    ds_read_b128 v[52:55], v12 offset:40960
    v_mfma_f32_16x16x32_bf16 v[236:239], v[60:63], v[124:127], v[236:239]
    v_exp_f32 v219, v219
    v_cvt_pk_bf16_f32 v164, v216, v217
    v_mfma_f32_16x16x32_bf16 v[192:195], v[32:35], v[64:67], v[240:243]
    ds_read_b128 v[56:59], v13 offset:32768
    v_mfma_f32_16x16x32_bf16 v[200:203], v[32:35], v[68:71], v[244:247]
    s_waitcnt lgkmcnt(4)
    v_exp_f32 v220, v220
    v_exp_f32 v221, v221
    v_mfma_f32_16x16x32_bf16 v[196:199], v[36:39], v[64:67], v[240:243]
    ds_read_b128 v[60:63], v13 offset:40960
    v_cvt_pk_bf16_f32 v165, v218, v219
    v_mfma_f32_16x16x32_bf16 v[204:207], v[36:39], v[68:71], v[244:247]
    v_exp_f32 v222, v222
    v_mfma_f32_16x16x32_bf16 v[192:195], v[40:43], v[72:75], v[192:195]
    ds_read_b32 v4, v1 offset:1024
    ds_read_b128 v[32:35], v10 offset:33024
    v_mfma_f32_16x16x32_bf16 v[200:203], v[40:43], v[76:79], v[200:203]
    s_waitcnt lgkmcnt(5)
    v_exp_f32 v223, v223
    v_cvt_pk_bf16_f32 v166, v220, v221
    v_cvt_pk_bf16_f32 v167, v222, v223
    v_mfma_f32_16x16x32_bf16 v[196:199], v[44:47], v[72:75], v[196:199]
    ds_read_b128 v[36:39], v10 offset:41216
    v_max3_f32 v20, v224, v225, v226
    v_mfma_f32_16x16x32_bf16 v[204:207], v[44:47], v[76:79], v[204:207]
    v_max3_f32 v20, v20, v227, v228
    v_subrev_u32 v10, 0x10000, v10
    v_mfma_f32_16x16x32_bf16 v[192:195], v[48:51], v[80:83], v[192:195]
    ds_read_b128 v[40:43], v11 offset:33024
    v_mfma_f32_16x16x32_bf16 v[200:203], v[48:51], v[84:87], v[200:203]
    s_waitcnt lgkmcnt(5)
    v_mfma_f32_16x16x32_bf16 v[248:251], v[24:27], v[160:163], v[248:251]
    v_max3_f32 v20, v20, v229, v230
    v_mfma_f32_16x16x32_bf16 v[196:199], v[52:55], v[80:83], v[196:199]
    ds_read_b128 v[44:47], v11 offset:41216
    v_max3_f32 v20, v20, v231, v232
    v_mfma_f32_16x16x32_bf16 v[204:207], v[52:55], v[84:87], v[204:207]
    v_max3_f32 v20, v20, v233, v234
    v_subrev_u32 v11, 0x10000, v11
    v_mfma_f32_16x16x32_bf16 v[192:195], v[56:59], v[88:91], v[192:195]
    ds_read_b128 v[48:51], v12 offset:33024
    v_mfma_f32_16x16x32_bf16 v[200:203], v[56:59], v[92:95], v[200:203]
    s_waitcnt lgkmcnt(4)
    v_mfma_f32_16x16x32_bf16 v[252:255], v[24:27], v[164:167], v[252:255]
    v_max3_f32 v20, v20, v235, v236
    v_mfma_f32_16x16x32_bf16 v[196:199], v[60:63], v[88:91], v[196:199]
    ds_read_b128 v[52:55], v12 offset:41216
    v_max3_f32 v20, v20, v237, v238
    v_mfma_f32_16x16x32_bf16 v[204:207], v[60:63], v[92:95], v[204:207]
    v_max_f32 v20, v20, v239
    v_subrev_u32 v12, 0x10000, v12
    v_mfma_f32_16x16x32_bf16 v[192:195], v[32:35], v[96:99], v[192:195]
    ds_read_b128 v[56:59], v13 offset:33024
    v_mfma_f32_16x16x32_bf16 v[200:203], v[32:35], v[100:103], v[200:203]
    s_waitcnt lgkmcnt(4)
    v_cmp_lt_f32 vcc, s40, v20
    s_cbranch_vccnz Ls_66
Lb_67:
    v_exp_f32 v224, v224
    v_exp_f32 v225, v225
    v_mfma_f32_16x16x32_bf16 v[196:199], v[36:39], v[96:99], v[196:199]
    ds_read_b128 v[60:63], v13 offset:41216
    v_mfma_f32_16x16x32_bf16 v[204:207], v[36:39], v[100:103], v[204:207]
    v_cmp_gt_u32 vcc, 8, v4
    v_exp_f32 v226, v226
    v_exp_f32 v227, v227
    v_subrev_u32 v13, 0x10000, v13
    s_cbranch_vccnz Ls_68
Lb_69:
    v_mfma_f32_16x16x32_bf16 v[192:195], v[40:43], v[104:107], v[192:195]
    ds_read_b128 v[32:35], v10 offset:0
    v_cvt_pk_bf16_f32 v168, v224, v225
    v_mfma_f32_16x16x32_bf16 v[200:203], v[40:43], v[108:111], v[200:203]
    s_waitcnt lgkmcnt(4)
    v_exp_f32 v228, v228
    v_mfma_f32_16x16x32_bf16 v[196:199], v[44:47], v[104:107], v[196:199]
    ds_read_b128 v[36:39], v10 offset:8192
    v_mfma_f32_16x16x32_bf16 v[204:207], v[44:47], v[108:111], v[204:207]
    v_exp_f32 v229, v229
    v_cvt_pk_bf16_f32 v169, v226, v227
    v_mfma_f32_16x16x32_bf16 v[192:195], v[48:51], v[112:115], v[192:195]
    ds_read_b128 v[40:43], v11 offset:0
    v_mfma_f32_16x16x32_bf16 v[200:203], v[48:51], v[116:119], v[200:203]
    s_waitcnt lgkmcnt(4)
    v_exp_f32 v230, v230
    v_exp_f32 v231, v231
    v_mfma_f32_16x16x32_bf16 v[196:199], v[52:55], v[112:115], v[196:199]
    ds_read_b128 v[44:47], v11 offset:8192
    v_cvt_pk_bf16_f32 v170, v228, v229
    v_mfma_f32_16x16x32_bf16 v[204:207], v[52:55], v[116:119], v[204:207]
    v_exp_f32 v232, v232
    v_exp_f32 v233, v233
    v_mfma_f32_16x16x32_bf16 v[192:195], v[56:59], v[120:123], v[192:195]
    ds_read_b128 v[48:51], v12 offset:0
    v_cvt_pk_bf16_f32 v171, v230, v231
    v_mfma_f32_16x16x32_bf16 v[200:203], v[56:59], v[124:127], v[200:203]
    s_waitcnt lgkmcnt(4)
    v_exp_f32 v234, v234
    v_mfma_f32_16x16x32_bf16 v[196:199], v[60:63], v[120:123], v[196:199]
    ds_read_b128 v[52:55], v12 offset:8192
    v_mfma_f32_16x16x32_bf16 v[204:207], v[60:63], v[124:127], v[204:207]
    v_exp_f32 v235, v235
    v_cvt_pk_bf16_f32 v172, v232, v233
    v_mfma_f32_16x16x32_bf16 v[208:211], v[32:35], v[64:67], v[240:243]
    ds_read_b128 v[56:59], v13 offset:0
    v_mfma_f32_16x16x32_bf16 v[216:219], v[32:35], v[68:71], v[244:247]
    s_waitcnt lgkmcnt(4)
    v_exp_f32 v236, v236
    v_exp_f32 v237, v237
    v_mfma_f32_16x16x32_bf16 v[212:215], v[36:39], v[64:67], v[240:243]
    ds_read_b128 v[60:63], v13 offset:8192
    v_cvt_pk_bf16_f32 v173, v234, v235
    v_mfma_f32_16x16x32_bf16 v[220:223], v[36:39], v[68:71], v[244:247]
    v_exp_f32 v238, v238
    v_mfma_f32_16x16x32_bf16 v[208:211], v[40:43], v[72:75], v[208:211]
    ds_read_b128 v[32:35], v10 offset:256
    v_mfma_f32_16x16x32_bf16 v[216:219], v[40:43], v[76:79], v[216:219]
    s_waitcnt lgkmcnt(4)
    v_exp_f32 v239, v239
    v_cvt_pk_bf16_f32 v174, v236, v237
    v_cvt_pk_bf16_f32 v175, v238, v239
    v_mfma_f32_16x16x32_bf16 v[212:215], v[44:47], v[72:75], v[212:215]
    ds_read_b128 v[36:39], v10 offset:8448
    v_max3_f32 v20, v192, v193, v194
    v_mfma_f32_16x16x32_bf16 v[220:223], v[44:47], v[76:79], v[220:223]
    v_max3_f32 v20, v20, v195, v196
    v_mfma_f32_16x16x32_bf16 v[208:211], v[48:51], v[80:83], v[208:211]
    ds_read_b128 v[40:43], v11 offset:256
    v_mfma_f32_16x16x32_bf16 v[216:219], v[48:51], v[84:87], v[216:219]
    s_waitcnt lgkmcnt(4)
    v_mfma_f32_16x16x32_bf16 v[248:251], v[24:27], v[168:171], v[248:251]
    v_max3_f32 v20, v20, v197, v198
    v_mfma_f32_16x16x32_bf16 v[212:215], v[52:55], v[80:83], v[212:215]
    ds_read_b128 v[44:47], v11 offset:8448
    v_max3_f32 v20, v20, v199, v200
    v_mfma_f32_16x16x32_bf16 v[220:223], v[52:55], v[84:87], v[220:223]
    v_max3_f32 v20, v20, v201, v202
    v_mfma_f32_16x16x32_bf16 v[208:211], v[56:59], v[88:91], v[208:211]
    ds_read_b128 v[48:51], v12 offset:256
    v_mfma_f32_16x16x32_bf16 v[216:219], v[56:59], v[92:95], v[216:219]
    s_waitcnt lgkmcnt(4)
    v_mfma_f32_16x16x32_bf16 v[252:255], v[24:27], v[172:175], v[252:255]
    v_max3_f32 v20, v20, v203, v204
    v_mfma_f32_16x16x32_bf16 v[212:215], v[60:63], v[88:91], v[212:215]
    ds_read_b128 v[52:55], v12 offset:8448
    v_max3_f32 v20, v20, v205, v206
    v_mfma_f32_16x16x32_bf16 v[220:223], v[60:63], v[92:95], v[220:223]
    v_max_f32 v20, v20, v207
    v_mfma_f32_16x16x32_bf16 v[208:211], v[32:35], v[96:99], v[208:211]
    ds_read_b128 v[56:59], v13 offset:256
    v_mfma_f32_16x16x32_bf16 v[216:219], v[32:35], v[100:103], v[216:219]
    s_waitcnt lgkmcnt(4)
    v_cmp_lt_f32 vcc, s40, v20
    s_cbranch_vccnz Ls_70
Lb_71:
    v_exp_f32 v192, v192
    v_exp_f32 v193, v193
    v_mfma_f32_16x16x32_bf16 v[212:215], v[36:39], v[96:99], v[212:215]
    ds_read_b128 v[60:63], v13 offset:8448
    v_mfma_f32_16x16x32_bf16 v[220:223], v[36:39], v[100:103], v[220:223]
    v_exp_f32 v194, v194
    v_exp_f32 v195, v195
    v_mfma_f32_16x16x32_bf16 v[208:211], v[40:43], v[104:107], v[208:211]
    v_cvt_pk_bf16_f32 v176, v192, v193
    v_mfma_f32_16x16x32_bf16 v[216:219], v[40:43], v[108:111], v[216:219]
    s_waitcnt lgkmcnt(3)
    v_exp_f32 v196, v196
    v_mfma_f32_16x16x32_bf16 v[212:215], v[44:47], v[104:107], v[212:215]
    v_mfma_f32_16x16x32_bf16 v[220:223], v[44:47], v[108:111], v[220:223]
    v_exp_f32 v197, v197
    v_cvt_pk_bf16_f32 v177, v194, v195
    v_mfma_f32_16x16x32_bf16 v[208:211], v[48:51], v[112:115], v[208:211]
    v_mfma_f32_16x16x32_bf16 v[216:219], v[48:51], v[116:119], v[216:219]
    s_waitcnt lgkmcnt(1)
    v_exp_f32 v198, v198
    v_exp_f32 v199, v199
    v_mfma_f32_16x16x32_bf16 v[212:215], v[52:55], v[112:115], v[212:215]
    v_cvt_pk_bf16_f32 v178, v196, v197
    v_mfma_f32_16x16x32_bf16 v[220:223], v[52:55], v[116:119], v[220:223]
    v_exp_f32 v200, v200
    v_exp_f32 v201, v201
    v_mfma_f32_16x16x32_bf16 v[208:211], v[56:59], v[120:123], v[208:211]
    v_cvt_pk_bf16_f32 v179, v198, v199
    v_mfma_f32_16x16x32_bf16 v[216:219], v[56:59], v[124:127], v[216:219]
    s_waitcnt lgkmcnt(0)
    v_exp_f32 v202, v202
    v_mfma_f32_16x16x32_bf16 v[212:215], v[60:63], v[120:123], v[212:215]
    v_mfma_f32_16x16x32_bf16 v[220:223], v[60:63], v[124:127], v[220:223]
    s_add_u32 m0, s0, 4036
    s_nop 0
    global_load_lds_dword v7, s[16:17] offset:60
    v_exp_f32 v203, v203
    v_cvt_pk_bf16_f32 v180, v200, v201
    v_mov_b32 v4, 0
    v_cmp_gt_u32 vcc, 1, v4
    s_cbranch_vccnz Ls_72
Lb_73:
    ds_read_b64_tr_b16 v[32:33], v14 offset:0
    ds_read_b64_tr_b16 v[34:35], v14 offset:2048
    ds_read_b64_tr_b16 v[36:37], v15 offset:0
    ds_read_b64_tr_b16 v[38:39], v15 offset:2048
    ds_read_b32 v4, v1 offset:2048
    ds_read_b64_tr_b16 v[40:41], v16 offset:0
    ds_read_b64_tr_b16 v[42:43], v16 offset:2048
    ds_read_b64_tr_b16 v[44:45], v17 offset:0
    ds_read_b64_tr_b16 v[46:47], v17 offset:2048
    ds_read_b64_tr_b16 v[48:49], v14 offset:4096
    ds_read_b64_tr_b16 v[50:51], v14 offset:6144
    v_exp_f32 v204, v204
    v_exp_f32 v205, v205
    v_cvt_pk_bf16_f32 v181, v202, v203
    v_exp_f32 v206, v206
    v_exp_f32 v207, v207
    v_cvt_pk_bf16_f32 v182, v204, v205
    v_cvt_pk_bf16_f32 v183, v206, v207
    v_max3_f32 v20, v208, v209, v210
    v_max3_f32 v20, v20, v211, v212
    v_mfma_f32_16x16x32_bf16 v[248:251], v[24:27], v[176:179], v[248:251]
    v_mfma_f32_16x16x32_bf16 v[252:255], v[24:27], v[180:183], v[252:255]
    v_max3_f32 v20, v20, v213, v214
    v_max3_f32 v20, v20, v215, v216
    v_max3_f32 v20, v20, v217, v218
    v_max3_f32 v20, v20, v219, v220
    v_max3_f32 v20, v20, v221, v222
    v_max_f32 v20, v20, v223
    v_cmp_lt_f32 vcc, s40, v20
    s_cbranch_vccnz Ls_74
Lb_75:
    s_waitcnt lgkmcnt(9)
    v_mfma_f32_16x16x32_bf16 v[64:67], v[32:35], v[128:131], 0
    ds_read_b64_tr_b16 v[52:53], v15 offset:4096
    ds_read_b64_tr_b16 v[54:55], v15 offset:6144
    v_mfma_f32_16x16x32_bf16 v[72:75], v[32:35], v[132:135], 0
    s_waitcnt lgkmcnt(6)
    v_exp_f32 v208, v208
    v_mfma_f32_16x16x32_bf16 v[68:71], v[36:39], v[128:131], 0
    ds_read_b64_tr_b16 v[56:57], v16 offset:4096
    ds_read_b64_tr_b16 v[58:59], v16 offset:6144
    v_mfma_f32_16x16x32_bf16 v[76:79], v[36:39], v[132:135], 0
    v_exp_f32 v209, v209
    v_mfma_f32_16x16x32_bf16 v[80:83], v[40:43], v[128:131], 0
    ds_read_b64_tr_b16 v[60:61], v17 offset:4096
    ds_read_b64_tr_b16 v[62:63], v17 offset:6144
    v_mfma_f32_16x16x32_bf16 v[88:91], v[40:43], v[132:135], 0
    s_waitcnt lgkmcnt(6)
    v_cmp_gt_u32 vcc, 2, v4
    v_exp_f32 v210, v210
    s_cbranch_vccnz Ls_76
Lb_77:
    v_mfma_f32_16x16x32_bf16 v[84:87], v[44:47], v[128:131], 0
    ds_read_b64_tr_b16 v[32:33], v14 offset:8192
    ds_read_b64_tr_b16 v[34:35], v14 offset:10240
    v_mfma_f32_16x16x32_bf16 v[92:95], v[44:47], v[132:135], 0
    v_exp_f32 v211, v211
    v_cvt_pk_bf16_f32 v184, v208, v209
    v_mfma_f32_16x16x32_bf16 v[64:67], v[48:51], v[136:139], v[64:67]
    ds_read_b64_tr_b16 v[36:37], v15 offset:8192
    ds_read_b64_tr_b16 v[38:39], v15 offset:10240
    v_mfma_f32_16x16x32_bf16 v[72:75], v[48:51], v[140:143], v[72:75]
    s_waitcnt lgkmcnt(6)
    v_exp_f32 v212, v212
    v_mfma_f32_16x16x32_bf16 v[68:71], v[52:55], v[136:139], v[68:71]
    ds_read_b32 v4, v1 offset:2048
    ds_read_b64_tr_b16 v[40:41], v16 offset:8192
    ds_read_b64_tr_b16 v[42:43], v16 offset:10240
    v_mfma_f32_16x16x32_bf16 v[76:79], v[52:55], v[140:143], v[76:79]
    v_exp_f32 v213, v213
    v_mfma_f32_16x16x32_bf16 v[80:83], v[56:59], v[136:139], v[80:83]
    ds_read_b64_tr_b16 v[44:45], v17 offset:8192
    ds_read_b64_tr_b16 v[46:47], v17 offset:10240
    v_mfma_f32_16x16x32_bf16 v[88:91], v[56:59], v[140:143], v[88:91]
    s_waitcnt lgkmcnt(7)
    v_cvt_pk_bf16_f32 v185, v210, v211
    v_mfma_f32_16x16x32_bf16 v[84:87], v[60:63], v[136:139], v[84:87]
    ds_read_b64_tr_b16 v[48:49], v14 offset:12288
    ds_read_b64_tr_b16 v[50:51], v14 offset:14336
    v_mfma_f32_16x16x32_bf16 v[92:95], v[60:63], v[140:143], v[92:95]
    v_exp_f32 v214, v214
    v_exp_f32 v215, v215
    v_mfma_f32_16x16x32_bf16 v[64:67], v[32:35], v[144:147], v[64:67]
    ds_read_b64_tr_b16 v[52:53], v15 offset:12288
    ds_read_b64_tr_b16 v[54:55], v15 offset:14336
    v_mfma_f32_16x16x32_bf16 v[72:75], v[32:35], v[148:151], v[72:75]
    s_waitcnt lgkmcnt(6)
    v_cvt_pk_bf16_f32 v186, v212, v213
    v_mfma_f32_16x16x32_bf16 v[68:71], v[36:39], v[144:147], v[68:71]
    ds_read_b64_tr_b16 v[56:57], v16 offset:12288
    ds_read_b64_tr_b16 v[58:59], v16 offset:14336
    v_mfma_f32_16x16x32_bf16 v[76:79], v[36:39], v[148:151], v[76:79]
    v_exp_f32 v216, v216
    v_mfma_f32_16x16x32_bf16 v[80:83], v[40:43], v[144:147], v[80:83]
    ds_read_b64_tr_b16 v[60:61], v17 offset:12288
    ds_read_b64_tr_b16 v[62:63], v17 offset:14336
    v_mfma_f32_16x16x32_bf16 v[88:91], v[40:43], v[148:151], v[88:91]
    s_waitcnt lgkmcnt(6)
    v_cmp_gt_u32 vcc, 3, v4
    v_exp_f32 v217, v217
    s_cbranch_vccnz Ls_78
Lb_79:
    v_mfma_f32_16x16x32_bf16 v[84:87], v[44:47], v[144:147], v[84:87]
    ds_read_b64_tr_b16 v[32:33], v14 offset:32768
    ds_read_b64_tr_b16 v[34:35], v14 offset:34816
    v_mfma_f32_16x16x32_bf16 v[92:95], v[44:47], v[148:151], v[92:95]
    v_cvt_pk_bf16_f32 v187, v214, v215
    v_exp_f32 v218, v218
    v_mfma_f32_16x16x32_bf16 v[64:67], v[48:51], v[152:155], v[64:67]
    ds_read_b64_tr_b16 v[36:37], v15 offset:32768
    ds_read_b64_tr_b16 v[38:39], v15 offset:34816
    v_mfma_f32_16x16x32_bf16 v[72:75], v[48:51], v[156:159], v[72:75]
    s_waitcnt lgkmcnt(6)
    v_exp_f32 v219, v219
    v_mfma_f32_16x16x32_bf16 v[68:71], v[52:55], v[152:155], v[68:71]
    ds_read_b32 v4, v1 offset:2048
    ds_read_b64_tr_b16 v[40:41], v16 offset:32768
    ds_read_b64_tr_b16 v[42:43], v16 offset:34816
    v_mfma_f32_16x16x32_bf16 v[76:79], v[52:55], v[156:159], v[76:79]
    v_cvt_pk_bf16_f32 v188, v216, v217
    v_mfma_f32_16x16x32_bf16 v[80:83], v[56:59], v[152:155], v[80:83]
    ds_read_b64_tr_b16 v[44:45], v17 offset:32768
    ds_read_b64_tr_b16 v[46:47], v17 offset:34816
    v_mfma_f32_16x16x32_bf16 v[88:91], v[56:59], v[156:159], v[88:91]
    s_waitcnt lgkmcnt(7)
    v_exp_f32 v220, v220
    v_mfma_f32_16x16x32_bf16 v[84:87], v[60:63], v[152:155], v[84:87]
    ds_read_b64_tr_b16 v[48:49], v14 offset:36864
    ds_read_b64_tr_b16 v[50:51], v14 offset:38912
    v_mfma_f32_16x16x32_bf16 v[92:95], v[60:63], v[156:159], v[92:95]
    v_exp_f32 v221, v221
    v_cvt_pk_bf16_f32 v189, v218, v219
    v_mfma_f32_16x16x32_bf16 v[64:67], v[32:35], v[160:163], v[64:67]
    ds_read_b64_tr_b16 v[52:53], v15 offset:36864
    ds_read_b64_tr_b16 v[54:55], v15 offset:38912
    v_mfma_f32_16x16x32_bf16 v[72:75], v[32:35], v[164:167], v[72:75]
    s_waitcnt lgkmcnt(6)
    v_exp_f32 v222, v222
    v_mfma_f32_16x16x32_bf16 v[68:71], v[36:39], v[160:163], v[68:71]
    ds_read_b64_tr_b16 v[56:57], v16 offset:36864
    ds_read_b64_tr_b16 v[58:59], v16 offset:38912
    v_mfma_f32_16x16x32_bf16 v[76:79], v[36:39], v[164:167], v[76:79]
    v_exp_f32 v223, v223
    v_mfma_f32_16x16x32_bf16 v[80:83], v[40:43], v[160:163], v[80:83]
    ds_read_b64_tr_b16 v[60:61], v17 offset:36864
    ds_read_b64_tr_b16 v[62:63], v17 offset:38912
    v_mfma_f32_16x16x32_bf16 v[88:91], v[40:43], v[164:167], v[88:91]
    s_waitcnt lgkmcnt(6)
    v_cmp_gt_u32 vcc, 4, v4
    v_cvt_pk_bf16_f32 v190, v220, v221
    v_cvt_pk_bf16_f32 v191, v222, v223
    s_cbranch_vccnz Ls_80
Lb_81:
    v_mfma_f32_16x16x32_bf16 v[84:87], v[44:47], v[160:163], v[84:87]
    ds_read_b64_tr_b16 v[32:33], v14 offset:40960
    ds_read_b64_tr_b16 v[34:35], v14 offset:43008
    v_mfma_f32_16x16x32_bf16 v[92:95], v[44:47], v[164:167], v[92:95]
    v_mfma_f32_16x16x32_bf16 v[64:67], v[48:51], v[168:171], v[64:67]
    ds_read_b64_tr_b16 v[36:37], v15 offset:40960
    ds_read_b64_tr_b16 v[38:39], v15 offset:43008
    v_mfma_f32_16x16x32_bf16 v[72:75], v[48:51], v[172:175], v[72:75]
    s_waitcnt lgkmcnt(6)
    v_mfma_f32_16x16x32_bf16 v[248:251], v[24:27], v[184:187], v[248:251]
    v_mfma_f32_16x16x32_bf16 v[68:71], v[52:55], v[168:171], v[68:71]
    ds_read_b64_tr_b16 v[40:41], v16 offset:40960
    ds_read_b64_tr_b16 v[42:43], v16 offset:43008
    v_mfma_f32_16x16x32_bf16 v[76:79], v[52:55], v[172:175], v[76:79]
    v_mfma_f32_16x16x32_bf16 v[252:255], v[24:27], v[188:191], v[252:255]
    v_mfma_f32_16x16x32_bf16 v[80:83], v[56:59], v[168:171], v[80:83]
    ds_read_b64_tr_b16 v[44:45], v17 offset:40960
    ds_read_b64_tr_b16 v[46:47], v17 offset:43008
    v_mfma_f32_16x16x32_bf16 v[88:91], v[56:59], v[172:175], v[88:91]
    s_waitcnt lgkmcnt(6)
    v_mfma_f32_16x16x32_bf16 v[84:87], v[60:63], v[168:171], v[84:87]
    ds_read_b64_tr_b16 v[48:49], v14 offset:45056
    ds_read_b64_tr_b16 v[50:51], v14 offset:47104
    v_mfma_f32_16x16x32_bf16 v[92:95], v[60:63], v[172:175], v[92:95]
    v_mfma_f32_16x16x32_bf16 v[64:67], v[32:35], v[176:179], v[64:67]
    ds_read_b64_tr_b16 v[52:53], v15 offset:45056
    ds_read_b64_tr_b16 v[54:55], v15 offset:47104
    v_mfma_f32_16x16x32_bf16 v[72:75], v[32:35], v[180:183], v[72:75]
    s_waitcnt lgkmcnt(6)
    v_mfma_f32_16x16x32_bf16 v[68:71], v[36:39], v[176:179], v[68:71]
    ds_read_b64_tr_b16 v[56:57], v16 offset:45056
    ds_read_b64_tr_b16 v[58:59], v16 offset:47104
    v_mfma_f32_16x16x32_bf16 v[76:79], v[36:39], v[180:183], v[76:79]
    v_permlane32_swap_b32 v248, v252
    v_mov_b32 v8, v22
    v_mfma_f32_16x16x32_bf16 v[80:83], v[40:43], v[176:179], v[80:83]
    ds_read_b32 v4, v1 offset:2048
    ds_read_b64_tr_b16 v[60:61], v17 offset:45056
    ds_read_b64_tr_b16 v[62:63], v17 offset:47104
    v_mfma_f32_16x16x32_bf16 v[88:91], v[40:43], v[180:183], v[88:91]
    s_waitcnt lgkmcnt(7)
    v_mov_b32 v9, v248
    v_add3_u32 v10, v8, v9, s26
    v_mfma_f32_16x16x32_bf16 v[84:87], v[44:47], v[176:179], v[84:87]
    v_mfma_f32_16x16x32_bf16 v[92:95], v[44:47], v[180:183], v[92:95]
    v_mfma_f32_16x16x32_bf16 v[64:67], v[48:51], v[184:187], v[64:67]
    v_mfma_f32_16x16x32_bf16 v[72:75], v[48:51], v[188:191], v[72:75]
    s_waitcnt lgkmcnt(3)
    v_mfma_f32_16x16x32_bf16 v[68:71], v[52:55], v[184:187], v[68:71]
    v_mfma_f32_16x16x32_bf16 v[76:79], v[52:55], v[188:191], v[76:79]
    v_mfma_f32_16x16x32_bf16 v[80:83], v[56:59], v[184:187], v[80:83]
    v_mfma_f32_16x16x32_bf16 v[88:91], v[56:59], v[188:191], v[88:91]
    s_waitcnt lgkmcnt(0)
    v_mfma_f32_16x16x32_bf16 v[84:87], v[60:63], v[184:187], v[84:87]
    v_mfma_f32_16x16x32_bf16 v[92:95], v[60:63], v[188:191], v[92:95]
    s_nop 3
    v_cvt_pk_bf16_f32 v224, v64, v65
    v_cvt_pk_bf16_f32 v225, v66, v67
    v_cvt_pk_bf16_f32 v226, v68, v69
    v_cvt_pk_bf16_f32 v227, v70, v71
    v_cvt_pk_bf16_f32 v228, v72, v73
    v_cvt_pk_bf16_f32 v229, v74, v75
    v_cvt_pk_bf16_f32 v230, v76, v77
    v_cvt_pk_bf16_f32 v231, v78, v79
    v_cvt_pk_bf16_f32 v232, v80, v81
    v_cvt_pk_bf16_f32 v233, v82, v83
    v_cvt_pk_bf16_f32 v234, v84, v85
    v_cvt_pk_bf16_f32 v235, v86, v87
    v_cvt_pk_bf16_f32 v236, v88, v89
    v_cvt_pk_bf16_f32 v237, v90, v91
    v_cvt_pk_bf16_f32 v238, v92, v93
    v_cvt_pk_bf16_f32 v239, v94, v95
    v_add3_u32 v11, v224, v225, s53
    v_add3_u32 v11, v11, v226, v227
    v_add3_u32 v11, v11, v228, v229
    v_add3_u32 v11, v11, v230, v231
    v_add3_u32 v11, v11, v232, v233
    v_add3_u32 v11, v11, v234, v235
    v_add3_u32 v11, v11, v236, v237
    v_add3_u32 v11, v11, v238, v239
    buffer_store_dwordx4 v[224:227], v5, s[32:35], s66 offen offset:0
    buffer_store_dwordx4 v[228:231], v5, s[32:35], s66 offen offset:1024
    buffer_store_dwordx4 v[232:235], v5, s[32:35], s66 offen offset:2048
    buffer_store_dwordx4 v[236:239], v5, s[32:35], s66 offen offset:3072
    buffer_store_dword v11, v23, s[32:35], s44 offen
    buffer_store_dwordx3 v[8:10], v6, s[32:35], s44 offen offset:256
    s_cmp_lg_u32 s30, 0
    s_cbranch_scc1 Ls_82
Lb_83:
    v_cmp_gt_u32 vcc, 5, v4
    s_cbranch_vccnz Ls_84
Lb_85:
    ds_read_b64_tr_b16 v[32:33], v14 offset:49152
    ds_read_b64_tr_b16 v[34:35], v14 offset:51200
    ds_read_b64_tr_b16 v[36:37], v15 offset:49152
    ds_read_b64_tr_b16 v[38:39], v15 offset:51200
    ds_read_b32 v4, v1 offset:2048
    ds_read_b64_tr_b16 v[40:41], v16 offset:49152
    ds_read_b64_tr_b16 v[42:43], v16 offset:51200
    ds_read_b64_tr_b16 v[44:45], v17 offset:49152
    ds_read_b64_tr_b16 v[46:47], v17 offset:51200
    ds_read_b64_tr_b16 v[48:49], v14 offset:53248
    ds_read_b64_tr_b16 v[50:51], v14 offset:55296
    s_waitcnt lgkmcnt(9)
    v_mfma_f32_16x16x32_bf16 v[64:67], v[32:35], v[128:131], 0
    ds_read_b64_tr_b16 v[52:53], v15 offset:53248
    ds_read_b64_tr_b16 v[54:55], v15 offset:55296
    v_mfma_f32_16x16x32_bf16 v[72:75], v[32:35], v[132:135], 0
    s_waitcnt lgkmcnt(6)
    v_mfma_f32_16x16x32_bf16 v[68:71], v[36:39], v[128:131], 0
    ds_read_b64_tr_b16 v[56:57], v16 offset:53248
    ds_read_b64_tr_b16 v[58:59], v16 offset:55296
    v_mfma_f32_16x16x32_bf16 v[76:79], v[36:39], v[132:135], 0
    v_mfma_f32_16x16x32_bf16 v[80:83], v[40:43], v[128:131], 0
    ds_read_b64_tr_b16 v[60:61], v17 offset:53248
    ds_read_b64_tr_b16 v[62:63], v17 offset:55296
    v_mfma_f32_16x16x32_bf16 v[88:91], v[40:43], v[132:135], 0
    s_waitcnt lgkmcnt(6)
    v_cmp_gt_u32 vcc, 6, v4
    s_cbranch_vccnz Ls_86
Lb_87:
    v_mfma_f32_16x16x32_bf16 v[84:87], v[44:47], v[128:131], 0
    ds_read_b64_tr_b16 v[32:33], v14 offset:57344
    ds_read_b64_tr_b16 v[34:35], v14 offset:59392
    v_mfma_f32_16x16x32_bf16 v[92:95], v[44:47], v[132:135], 0
    v_mfma_f32_16x16x32_bf16 v[64:67], v[48:51], v[136:139], v[64:67]
    ds_read_b64_tr_b16 v[36:37], v15 offset:57344
    ds_read_b64_tr_b16 v[38:39], v15 offset:59392
    v_mfma_f32_16x16x32_bf16 v[72:75], v[48:51], v[140:143], v[72:75]
    s_waitcnt lgkmcnt(6)
    v_mfma_f32_16x16x32_bf16 v[68:71], v[52:55], v[136:139], v[68:71]
    ds_read_b32 v4, v1 offset:2048
    ds_read_b64_tr_b16 v[40:41], v16 offset:57344
    ds_read_b64_tr_b16 v[42:43], v16 offset:59392
    v_mfma_f32_16x16x32_bf16 v[76:79], v[52:55], v[140:143], v[76:79]
    v_mfma_f32_16x16x32_bf16 v[80:83], v[56:59], v[136:139], v[80:83]
    ds_read_b64_tr_b16 v[44:45], v17 offset:57344
    ds_read_b64_tr_b16 v[46:47], v17 offset:59392
    v_mfma_f32_16x16x32_bf16 v[88:91], v[56:59], v[140:143], v[88:91]
    s_waitcnt lgkmcnt(7)
    v_mfma_f32_16x16x32_bf16 v[84:87], v[60:63], v[136:139], v[84:87]
    ds_read_b64_tr_b16 v[48:49], v14 offset:61440
    ds_read_b64_tr_b16 v[50:51], v14 offset:63488
    v_mfma_f32_16x16x32_bf16 v[92:95], v[60:63], v[140:143], v[92:95]
    v_mfma_f32_16x16x32_bf16 v[64:67], v[32:35], v[144:147], v[64:67]
    ds_read_b64_tr_b16 v[52:53], v15 offset:61440
    ds_read_b64_tr_b16 v[54:55], v15 offset:63488
    v_mfma_f32_16x16x32_bf16 v[72:75], v[32:35], v[148:151], v[72:75]
    s_waitcnt lgkmcnt(6)
    v_mfma_f32_16x16x32_bf16 v[68:71], v[36:39], v[144:147], v[68:71]
    ds_read_b64_tr_b16 v[56:57], v16 offset:61440
    ds_read_b64_tr_b16 v[58:59], v16 offset:63488
    v_mfma_f32_16x16x32_bf16 v[76:79], v[36:39], v[148:151], v[76:79]
    v_mfma_f32_16x16x32_bf16 v[80:83], v[40:43], v[144:147], v[80:83]
    ds_read_b64_tr_b16 v[60:61], v17 offset:61440
    ds_read_b64_tr_b16 v[62:63], v17 offset:63488
    v_mfma_f32_16x16x32_bf16 v[88:91], v[40:43], v[148:151], v[88:91]
    s_waitcnt lgkmcnt(6)
    v_cmp_gt_u32 vcc, 7, v4
    v_add_u32 v14, 0x10000, v14
    v_add_u32 v15, 0x10000, v15
    v_add_u32 v16, 0x10000, v16
    v_add_u32 v17, 0x10000, v17
    s_cbranch_vccnz Ls_88
Lb_89:
    v_mfma_f32_16x16x32_bf16 v[84:87], v[44:47], v[144:147], v[84:87]
    ds_read_b64_tr_b16 v[32:33], v14 offset:0
    ds_read_b64_tr_b16 v[34:35], v14 offset:2048
    v_mfma_f32_16x16x32_bf16 v[92:95], v[44:47], v[148:151], v[92:95]
    v_mfma_f32_16x16x32_bf16 v[64:67], v[48:51], v[152:155], v[64:67]
    ds_read_b64_tr_b16 v[36:37], v15 offset:0
    ds_read_b64_tr_b16 v[38:39], v15 offset:2048
    v_mfma_f32_16x16x32_bf16 v[72:75], v[48:51], v[156:159], v[72:75]
    s_waitcnt lgkmcnt(6)
    v_mfma_f32_16x16x32_bf16 v[68:71], v[52:55], v[152:155], v[68:71]
    ds_read_b32 v4, v1 offset:2048
    ds_read_b64_tr_b16 v[40:41], v16 offset:0
    ds_read_b64_tr_b16 v[42:43], v16 offset:2048
    v_mfma_f32_16x16x32_bf16 v[76:79], v[52:55], v[156:159], v[76:79]
    v_mfma_f32_16x16x32_bf16 v[80:83], v[56:59], v[152:155], v[80:83]
    ds_read_b64_tr_b16 v[44:45], v17 offset:0
    ds_read_b64_tr_b16 v[46:47], v17 offset:2048
    v_mfma_f32_16x16x32_bf16 v[88:91], v[56:59], v[156:159], v[88:91]
    s_waitcnt lgkmcnt(7)
    s_cmp_lg_u32 s30, 0
    s_cbranch_scc1 Ls_90
Lb_91:
    buffer_load_dwordx4 v[192:195], v5, s[32:35], s67 offen offset:0 sc1
    buffer_load_dwordx4 v[196:199], v5, s[32:35], s67 offen offset:1024 sc1
    buffer_load_dwordx4 v[200:203], v5, s[32:35], s67 offen offset:2048 sc1
    buffer_load_dwordx4 v[204:207], v5, s[32:35], s67 offen offset:3072 sc1
    buffer_load_dword v12, v23, s[32:35], s45 offen sc1
    v_mfma_f32_16x16x32_bf16 v[84:87], v[60:63], v[152:155], v[84:87]
    ds_read_b64_tr_b16 v[48:49], v14 offset:4096
    ds_read_b64_tr_b16 v[50:51], v14 offset:6144
    v_mfma_f32_16x16x32_bf16 v[92:95], v[60:63], v[156:159], v[92:95]
    v_mfma_f32_16x16x32_bf16 v[64:67], v[32:35], v[160:163], v[64:67]
    ds_read_b64_tr_b16 v[52:53], v15 offset:4096
    ds_read_b64_tr_b16 v[54:55], v15 offset:6144
    v_mfma_f32_16x16x32_bf16 v[72:75], v[32:35], v[164:167], v[72:75]
    s_waitcnt lgkmcnt(6)
    v_mfma_f32_16x16x32_bf16 v[68:71], v[36:39], v[160:163], v[68:71]
    ds_read_b64_tr_b16 v[56:57], v16 offset:4096
    ds_read_b64_tr_b16 v[58:59], v16 offset:6144
    v_mfma_f32_16x16x32_bf16 v[76:79], v[36:39], v[164:167], v[76:79]
    v_mfma_f32_16x16x32_bf16 v[80:83], v[40:43], v[160:163], v[80:83]
    ds_read_b64_tr_b16 v[60:61], v17 offset:4096
    ds_read_b64_tr_b16 v[62:63], v17 offset:6144
    v_mfma_f32_16x16x32_bf16 v[88:91], v[40:43], v[164:167], v[88:91]
    s_waitcnt lgkmcnt(6)
    s_cmp_lg_u32 s30, 0
    s_cbranch_scc1 Ls_92
Lb_93:
    buffer_load_dwordx3 v[240:242], v6, s[32:35], s45 offen offset:256 sc1
    buffer_load_dwordx3 v[244:246], v6, s[32:35], s46 offen offset:256 sc1
    buffer_load_dwordx3 v[248:250], v6, s[32:35], s47 offen offset:256 sc1
    v_cmp_gt_u32 vcc, 8, v4
    s_cbranch_vccnz Ls_94
Lb_95:
    v_mfma_f32_16x16x32_bf16 v[84:87], v[44:47], v[160:163], v[84:87]
    ds_read_b64_tr_b16 v[32:33], v14 offset:8192
    ds_read_b64_tr_b16 v[34:35], v14 offset:10240
    v_mfma_f32_16x16x32_bf16 v[92:95], v[44:47], v[164:167], v[92:95]
    v_mfma_f32_16x16x32_bf16 v[64:67], v[48:51], v[168:171], v[64:67]
    ds_read_b64_tr_b16 v[36:37], v15 offset:8192
    ds_read_b64_tr_b16 v[38:39], v15 offset:10240
    v_mfma_f32_16x16x32_bf16 v[72:75], v[48:51], v[172:175], v[72:75]
    s_waitcnt lgkmcnt(6)
    v_mfma_f32_16x16x32_bf16 v[68:71], v[52:55], v[168:171], v[68:71]
    ds_read_b64_tr_b16 v[40:41], v16 offset:8192
    ds_read_b64_tr_b16 v[42:43], v16 offset:10240
    v_mfma_f32_16x16x32_bf16 v[76:79], v[52:55], v[172:175], v[76:79]
    v_mfma_f32_16x16x32_bf16 v[80:83], v[56:59], v[168:171], v[80:83]
    ds_read_b64_tr_b16 v[44:45], v17 offset:8192
    ds_read_b64_tr_b16 v[46:47], v17 offset:10240
    v_mfma_f32_16x16x32_bf16 v[88:91], v[56:59], v[172:175], v[88:91]
    s_waitcnt lgkmcnt(6)
    v_mfma_f32_16x16x32_bf16 v[84:87], v[60:63], v[168:171], v[84:87]
    ds_read_b64_tr_b16 v[48:49], v14 offset:12288
    ds_read_b64_tr_b16 v[50:51], v14 offset:14336
    v_mfma_f32_16x16x32_bf16 v[92:95], v[60:63], v[172:175], v[92:95]
    v_mfma_f32_16x16x32_bf16 v[64:67], v[32:35], v[176:179], v[64:67]
    ds_read_b64_tr_b16 v[52:53], v15 offset:12288
    ds_read_b64_tr_b16 v[54:55], v15 offset:14336
    v_mfma_f32_16x16x32_bf16 v[72:75], v[32:35], v[180:183], v[72:75]
    s_waitcnt lgkmcnt(6)
    v_mfma_f32_16x16x32_bf16 v[68:71], v[36:39], v[176:179], v[68:71]
    ds_read_b64_tr_b16 v[56:57], v16 offset:12288
    ds_read_b64_tr_b16 v[58:59], v16 offset:14336
    v_mfma_f32_16x16x32_bf16 v[76:79], v[36:39], v[180:183], v[76:79]
    v_mfma_f32_16x16x32_bf16 v[80:83], v[40:43], v[176:179], v[80:83]
    ds_read_b32 v4, v1 offset:2048
    ds_read_b64_tr_b16 v[60:61], v17 offset:12288
    ds_read_b64_tr_b16 v[62:63], v17 offset:14336
    v_mfma_f32_16x16x32_bf16 v[88:91], v[40:43], v[180:183], v[88:91]
    s_waitcnt lgkmcnt(7)
    v_mfma_f32_16x16x32_bf16 v[84:87], v[44:47], v[176:179], v[84:87]
    v_mfma_f32_16x16x32_bf16 v[92:95], v[44:47], v[180:183], v[92:95]
    v_mfma_f32_16x16x32_bf16 v[64:67], v[48:51], v[184:187], v[64:67]
    v_mfma_f32_16x16x32_bf16 v[72:75], v[48:51], v[188:191], v[72:75]
    s_waitcnt lgkmcnt(3)
    v_mfma_f32_16x16x32_bf16 v[68:71], v[52:55], v[184:187], v[68:71]
    v_mfma_f32_16x16x32_bf16 v[76:79], v[52:55], v[188:191], v[76:79]
    v_mfma_f32_16x16x32_bf16 v[80:83], v[56:59], v[184:187], v[80:83]
    v_mfma_f32_16x16x32_bf16 v[88:91], v[56:59], v[188:191], v[88:91]
    s_waitcnt lgkmcnt(0)
    v_mfma_f32_16x16x32_bf16 v[84:87], v[60:63], v[184:187], v[84:87]
    v_mfma_f32_16x16x32_bf16 v[92:95], v[60:63], v[188:191], v[92:95]
    s_nop 3
    v_cvt_pk_bf16_f32 v224, v64, v65
    v_cvt_pk_bf16_f32 v225, v66, v67
    v_cvt_pk_bf16_f32 v226, v68, v69
    v_cvt_pk_bf16_f32 v227, v70, v71
    v_cvt_pk_bf16_f32 v228, v72, v73
    v_cvt_pk_bf16_f32 v229, v74, v75
    v_cvt_pk_bf16_f32 v230, v76, v77
    v_cvt_pk_bf16_f32 v231, v78, v79
    v_cvt_pk_bf16_f32 v232, v80, v81
    v_cvt_pk_bf16_f32 v233, v82, v83
    v_cvt_pk_bf16_f32 v234, v84, v85
    v_cvt_pk_bf16_f32 v235, v86, v87
    v_cvt_pk_bf16_f32 v236, v88, v89
    v_cvt_pk_bf16_f32 v237, v90, v91
    v_cvt_pk_bf16_f32 v238, v92, v93
    v_cvt_pk_bf16_f32 v239, v94, v95
    v_add3_u32 v11, v224, v225, s54
    v_add3_u32 v11, v11, v226, v227
    v_add3_u32 v11, v11, v228, v229
    v_add3_u32 v11, v11, v230, v231
    v_add3_u32 v11, v11, v232, v233
    v_add3_u32 v11, v11, v234, v235
    v_add3_u32 v11, v11, v236, v237
    v_add3_u32 v11, v11, v238, v239
    v_cmp_gt_u32 vcc, 9, v4
    s_cbranch_vccnz Ls_96
Lb_97:
    ds_read_b64_tr_b16 v[32:33], v14 offset:16384
    ds_read_b64_tr_b16 v[34:35], v14 offset:18432
    ds_read_b64_tr_b16 v[36:37], v15 offset:16384
    ds_read_b64_tr_b16 v[38:39], v15 offset:18432
    ds_read_b32 v4, v1 offset:2048
    ds_read_b64_tr_b16 v[40:41], v16 offset:16384
    ds_read_b64_tr_b16 v[42:43], v16 offset:18432
    ds_read_b64_tr_b16 v[44:45], v17 offset:16384
    ds_read_b64_tr_b16 v[46:47], v17 offset:18432
    ds_read_b64_tr_b16 v[48:49], v14 offset:20480
    ds_read_b64_tr_b16 v[50:51], v14 offset:22528
    s_waitcnt lgkmcnt(9)
    v_mfma_f32_16x16x32_bf16 v[64:67], v[32:35], v[128:131], 0
    ds_read_b64_tr_b16 v[52:53], v15 offset:20480
    ds_read_b64_tr_b16 v[54:55], v15 offset:22528
    v_mfma_f32_16x16x32_bf16 v[72:75], v[32:35], v[132:135], 0
    s_waitcnt lgkmcnt(6)
    v_mfma_f32_16x16x32_bf16 v[68:71], v[36:39], v[128:131], 0
    ds_read_b64_tr_b16 v[56:57], v16 offset:20480
    ds_read_b64_tr_b16 v[58:59], v16 offset:22528
    v_mfma_f32_16x16x32_bf16 v[76:79], v[36:39], v[132:135], 0
    v_mfma_f32_16x16x32_bf16 v[80:83], v[40:43], v[128:131], 0
    ds_read_b64_tr_b16 v[60:61], v17 offset:20480
    ds_read_b64_tr_b16 v[62:63], v17 offset:22528
    v_mfma_f32_16x16x32_bf16 v[88:91], v[40:43], v[132:135], 0
    s_waitcnt lgkmcnt(6)
    v_cmp_gt_u32 vcc, 10, v4
    s_cbranch_vccnz Ls_98
Lb_99:
    v_mfma_f32_16x16x32_bf16 v[84:87], v[44:47], v[128:131], 0
    ds_read_b64_tr_b16 v[32:33], v14 offset:24576
    ds_read_b64_tr_b16 v[34:35], v14 offset:26624
    v_mfma_f32_16x16x32_bf16 v[92:95], v[44:47], v[132:135], 0
    v_mfma_f32_16x16x32_bf16 v[64:67], v[48:51], v[136:139], v[64:67]
    ds_read_b64_tr_b16 v[36:37], v15 offset:24576
    ds_read_b64_tr_b16 v[38:39], v15 offset:26624
    v_mfma_f32_16x16x32_bf16 v[72:75], v[48:51], v[140:143], v[72:75]
    s_waitcnt lgkmcnt(6)
    v_mfma_f32_16x16x32_bf16 v[68:71], v[52:55], v[136:139], v[68:71]
    ds_read_b32 v4, v1 offset:2048
    ds_read_b64_tr_b16 v[40:41], v16 offset:24576
    ds_read_b64_tr_b16 v[42:43], v16 offset:26624
    v_mfma_f32_16x16x32_bf16 v[76:79], v[52:55], v[140:143], v[76:79]
    v_mfma_f32_16x16x32_bf16 v[80:83], v[56:59], v[136:139], v[80:83]
    ds_read_b64_tr_b16 v[44:45], v17 offset:24576
    ds_read_b64_tr_b16 v[46:47], v17 offset:26624
    v_mfma_f32_16x16x32_bf16 v[88:91], v[56:59], v[140:143], v[88:91]
    s_waitcnt lgkmcnt(7)
    s_waitcnt vmcnt(3)
    v_add3_u32 v29, v192, v193, s53
    v_add3_u32 v29, v29, v194, v195
    v_add3_u32 v29, v29, v196, v197
    v_add3_u32 v29, v29, v198, v199
    v_add3_u32 v29, v29, v200, v201
    v_add3_u32 v29, v29, v202, v203
    v_add3_u32 v29, v29, v204, v205
    v_add3_u32 v29, v29, v206, v207
    v_cmp_ne_u32 vcc, v29, v12
    s_cbranch_vccnz Ls_100
Lb_101:
    buffer_store_dwordx4 v[224:227], v5, s[32:35], s67 offen offset:0
    buffer_store_dwordx4 v[228:231], v5, s[32:35], s67 offen offset:1024
    buffer_store_dwordx4 v[232:235], v5, s[32:35], s67 offen offset:2048
    buffer_store_dwordx4 v[236:239], v5, s[32:35], s67 offen offset:3072
    buffer_store_dword v11, v23, s[32:35], s45 offen
    s_cmp_lg_u32 s30, 0
    s_cbranch_scc1 Ls_104
Lb_105:
    v_mfma_f32_16x16x32_bf16 v[84:87], v[60:63], v[136:139], v[84:87]
    ds_read_b64_tr_b16 v[48:49], v14 offset:28672
    ds_read_b64_tr_b16 v[50:51], v14 offset:30720
    v_mfma_f32_16x16x32_bf16 v[92:95], v[60:63], v[140:143], v[92:95]
    v_mfma_f32_16x16x32_bf16 v[64:67], v[32:35], v[144:147], v[64:67]
    ds_read_b64_tr_b16 v[52:53], v15 offset:28672
    ds_read_b64_tr_b16 v[54:55], v15 offset:30720
    v_mfma_f32_16x16x32_bf16 v[72:75], v[32:35], v[148:151], v[72:75]
    s_waitcnt lgkmcnt(6)
    v_mfma_f32_16x16x32_bf16 v[68:71], v[36:39], v[144:147], v[68:71]
    ds_read_b64_tr_b16 v[56:57], v16 offset:28672
    ds_read_b64_tr_b16 v[58:59], v16 offset:30720
    v_mfma_f32_16x16x32_bf16 v[76:79], v[36:39], v[148:151], v[76:79]
    v_mfma_f32_16x16x32_bf16 v[80:83], v[40:43], v[144:147], v[80:83]
    ds_read_b64_tr_b16 v[60:61], v17 offset:28672
    ds_read_b64_tr_b16 v[62:63], v17 offset:30720
    v_mfma_f32_16x16x32_bf16 v[88:91], v[40:43], v[148:151], v[88:91]
    s_waitcnt lgkmcnt(6)
    s_waitcnt vmcnt(5)
Lv_106:
    v_add3_u32 v30, v240, v241, s26
    v_xor_b32 v242, v30, v242
    v_add3_u32 v30, v244, v245, s26
    v_xor_b32 v246, v30, v246
    v_add3_u32 v30, v248, v249, s26
    v_xor_b32 v250, v30, v250
    v_or3_b32 v30, v242, v246, v250
    v_cmp_ne_u32 vcc, 0, v30
    s_cbranch_vccnz Ls_107
Lb_108:
    v_max_f32 v30, v8, v240
    v_max3_f32 v30, v30, v244, v248
    v_sub_f32 v18, v8, v30
    v_cmp_gt_u32 vcc, 11, v4
    s_cbranch_vccnz Ls_111
Lb_112:
    v_mfma_f32_16x16x32_bf16 v[84:87], v[44:47], v[144:147], v[84:87]
    ds_read_b64_tr_b16 v[32:33], v14 offset:32768
    ds_read_b64_tr_b16 v[34:35], v14 offset:34816
    v_mfma_f32_16x16x32_bf16 v[92:95], v[44:47], v[148:151], v[92:95]
    v_sub_f32 v20, v240, v30
    v_sub_f32 v24, v244, v30
    v_sub_f32 v26, v248, v30
    v_exp_f32 v18, v18
    v_mfma_f32_16x16x32_bf16 v[64:67], v[48:51], v[152:155], v[64:67]
    ds_read_b64_tr_b16 v[36:37], v15 offset:32768
    ds_read_b64_tr_b16 v[38:39], v15 offset:34816
    v_mfma_f32_16x16x32_bf16 v[72:75], v[48:51], v[156:159], v[72:75]
    s_waitcnt lgkmcnt(6)
    v_exp_f32 v20, v20
    v_exp_f32 v24, v24
    v_exp_f32 v26, v26
    v_mul_f32 v30, v18, v9
    v_mfma_f32_16x16x32_bf16 v[68:71], v[52:55], v[152:155], v[68:71]
    ds_read_b32 v4, v1 offset:2048
    ds_read_b64_tr_b16 v[40:41], v16 offset:32768
    ds_read_b64_tr_b16 v[42:43], v16 offset:34816
    v_mfma_f32_16x16x32_bf16 v[76:79], v[52:55], v[156:159], v[76:79]
    v_fmac_f32 v30, v20, v241
    v_fmac_f32 v30, v24, v245
    v_fmac_f32 v30, v26, v249
    v_rcp_f32 v30, v30
    v_mfma_f32_16x16x32_bf16 v[80:83], v[56:59], v[152:155], v[80:83]
    ds_read_b64_tr_b16 v[44:45], v17 offset:32768
    ds_read_b64_tr_b16 v[46:47], v17 offset:34816
    v_mfma_f32_16x16x32_bf16 v[88:91], v[56:59], v[156:159], v[88:91]
    s_waitcnt lgkmcnt(7)
    s_nop 0
    v_mul_f32 v19, v18, v30
    v_mul_f32 v18, v18, v30
    v_mul_f32 v21, v20, v30
    v_mfma_f32_16x16x32_bf16 v[84:87], v[60:63], v[152:155], v[84:87]
    ds_read_b64_tr_b16 v[48:49], v14 offset:36864
    ds_read_b64_tr_b16 v[50:51], v14 offset:38912
    v_mfma_f32_16x16x32_bf16 v[92:95], v[60:63], v[156:159], v[92:95]
    v_mul_f32 v20, v20, v30
    v_mul_f32 v25, v24, v30
    v_mul_f32 v24, v24, v30
    v_mul_f32 v27, v26, v30
    v_mfma_f32_16x16x32_bf16 v[64:67], v[32:35], v[160:163], v[64:67]
    ds_read_b64_tr_b16 v[52:53], v15 offset:36864
    ds_read_b64_tr_b16 v[54:55], v15 offset:38912
    v_mfma_f32_16x16x32_bf16 v[72:75], v[32:35], v[164:167], v[72:75]
    s_waitcnt lgkmcnt(6)
    v_mul_f32 v26, v26, v30
    v_permlane32_swap_b32 v18, v19
    v_permlane32_swap_b32 v20, v21
    v_permlane32_swap_b32 v24, v25
    v_mfma_f32_16x16x32_bf16 v[68:71], v[36:39], v[160:163], v[68:71]
    ds_read_b64_tr_b16 v[56:57], v16 offset:36864
    ds_read_b64_tr_b16 v[58:59], v16 offset:38912
    v_mfma_f32_16x16x32_bf16 v[76:79], v[36:39], v[164:167], v[76:79]
    v_permlane32_swap_b32 v26, v27
    v_mfma_f32_16x16x32_bf16 v[80:83], v[40:43], v[160:163], v[80:83]
    ds_read_b64_tr_b16 v[60:61], v17 offset:36864
    ds_read_b64_tr_b16 v[62:63], v17 offset:38912
    v_mfma_f32_16x16x32_bf16 v[88:91], v[40:43], v[164:167], v[88:91]
    s_waitcnt lgkmcnt(6)
    s_cmp_lg_u32 s30, 0
    s_cbranch_scc1 Ls_113
Lb_114:
    buffer_load_dwordx4 v[208:211], v5, s[32:35], s69 offen offset:0 sc1
    buffer_load_dwordx4 v[212:215], v5, s[32:35], s69 offen offset:1024 sc1
    buffer_load_dwordx4 v[216:219], v5, s[32:35], s69 offen offset:2048 sc1
    buffer_load_dwordx4 v[220:223], v5, s[32:35], s69 offen offset:3072 sc1
    buffer_load_dword v13, v23, s[32:35], s47 offen sc1
    v_cmp_gt_u32 vcc, 12, v4
    s_cbranch_vccnz Ls_115
Lb_116:
    v_mfma_f32_16x16x32_bf16 v[84:87], v[44:47], v[160:163], v[84:87]
    ds_read_b64_tr_b16 v[32:33], v14 offset:40960
    ds_read_b64_tr_b16 v[34:35], v14 offset:43008
    v_mfma_f32_16x16x32_bf16 v[92:95], v[44:47], v[164:167], v[92:95]
    v_lshlrev_b32 v30, 16, v192
    v_and_b32 v31, 0xffff0000, v192
    v_mul_f32 v96, v30, v20
    v_mul_f32 v97, v31, v20
    v_mfma_f32_16x16x32_bf16 v[64:67], v[48:51], v[168:171], v[64:67]
    ds_read_b64_tr_b16 v[36:37], v15 offset:40960
    ds_read_b64_tr_b16 v[38:39], v15 offset:43008
    v_mfma_f32_16x16x32_bf16 v[72:75], v[48:51], v[172:175], v[72:75]
    s_waitcnt lgkmcnt(6)
    v_lshlrev_b32 v30, 16, v193
    v_and_b32 v31, 0xffff0000, v193
    v_mul_f32 v98, v30, v20
    v_mul_f32 v99, v31, v20
    v_mfma_f32_16x16x32_bf16 v[68:71], v[52:55], v[168:171], v[68:71]
    ds_read_b64_tr_b16 v[40:41], v16 offset:40960
    ds_read_b64_tr_b16 v[42:43], v16 offset:43008
    v_mfma_f32_16x16x32_bf16 v[76:79], v[52:55], v[172:175], v[76:79]
    v_lshlrev_b32 v30, 16, v194
    v_and_b32 v31, 0xffff0000, v194
    v_mul_f32 v100, v30, v20
    v_mul_f32 v101, v31, v20
    v_mfma_f32_16x16x32_bf16 v[80:83], v[56:59], v[168:171], v[80:83]
    ds_read_b64_tr_b16 v[44:45], v17 offset:40960
    ds_read_b64_tr_b16 v[46:47], v17 offset:43008
    v_mfma_f32_16x16x32_bf16 v[88:91], v[56:59], v[172:175], v[88:91]
    s_waitcnt lgkmcnt(6)
    v_lshlrev_b32 v30, 16, v195
    v_and_b32 v31, 0xffff0000, v195
    v_mul_f32 v102, v30, v20
    v_mul_f32 v103, v31, v20
    v_mfma_f32_16x16x32_bf16 v[84:87], v[60:63], v[168:171], v[84:87]
    ds_read_b64_tr_b16 v[48:49], v14 offset:45056
    ds_read_b64_tr_b16 v[50:51], v14 offset:47104
    v_mfma_f32_16x16x32_bf16 v[92:95], v[60:63], v[172:175], v[92:95]
    v_lshlrev_b32 v30, 16, v196
    v_and_b32 v31, 0xffff0000, v196
    v_mul_f32 v104, v30, v21
    v_mul_f32 v105, v31, v21
    v_mfma_f32_16x16x32_bf16 v[64:67], v[32:35], v[176:179], v[64:67]
    ds_read_b64_tr_b16 v[52:53], v15 offset:45056
    ds_read_b64_tr_b16 v[54:55], v15 offset:47104
    v_mfma_f32_16x16x32_bf16 v[72:75], v[32:35], v[180:183], v[72:75]
    s_waitcnt lgkmcnt(6)
    v_lshlrev_b32 v30, 16, v197
    v_and_b32 v31, 0xffff0000, v197
    v_mul_f32 v106, v30, v21
    v_mul_f32 v107, v31, v21
    v_mfma_f32_16x16x32_bf16 v[68:71], v[36:39], v[176:179], v[68:71]
    ds_read_b64_tr_b16 v[56:57], v16 offset:45056
    ds_read_b64_tr_b16 v[58:59], v16 offset:47104
    v_mfma_f32_16x16x32_bf16 v[76:79], v[36:39], v[180:183], v[76:79]
    v_lshlrev_b32 v30, 16, v198
    v_and_b32 v31, 0xffff0000, v198
    v_mul_f32 v108, v30, v21
    v_mul_f32 v109, v31, v21
    v_mfma_f32_16x16x32_bf16 v[80:83], v[40:43], v[176:179], v[80:83]
    ds_read_b32 v4, v1 offset:2048
    ds_read_b64_tr_b16 v[60:61], v17 offset:45056
    ds_read_b64_tr_b16 v[62:63], v17 offset:47104
    v_mfma_f32_16x16x32_bf16 v[88:91], v[40:43], v[180:183], v[88:91]
    s_waitcnt lgkmcnt(7)
    v_lshlrev_b32 v30, 16, v199
    v_and_b32 v31, 0xffff0000, v199
    v_mul_f32 v110, v30, v21
    v_mul_f32 v111, v31, v21
    v_mfma_f32_16x16x32_bf16 v[84:87], v[44:47], v[176:179], v[84:87]
    v_mfma_f32_16x16x32_bf16 v[92:95], v[44:47], v[180:183], v[92:95]
    v_lshlrev_b32 v30, 16, v200
    v_and_b32 v31, 0xffff0000, v200
    v_mul_f32 v112, v30, v20
    v_mul_f32 v113, v31, v20
    v_mfma_f32_16x16x32_bf16 v[64:67], v[48:51], v[184:187], v[64:67]
    v_mfma_f32_16x16x32_bf16 v[72:75], v[48:51], v[188:191], v[72:75]
    s_waitcnt lgkmcnt(3)
    v_lshlrev_b32 v30, 16, v201
    v_and_b32 v31, 0xffff0000, v201
    v_mul_f32 v114, v30, v20
    v_mul_f32 v115, v31, v20
    v_mfma_f32_16x16x32_bf16 v[68:71], v[52:55], v[184:187], v[68:71]
    v_mfma_f32_16x16x32_bf16 v[76:79], v[52:55], v[188:191], v[76:79]
    v_lshlrev_b32 v30, 16, v202
    v_and_b32 v31, 0xffff0000, v202
    v_mul_f32 v116, v30, v20
    v_mul_f32 v117, v31, v20
    v_mfma_f32_16x16x32_bf16 v[80:83], v[56:59], v[184:187], v[80:83]
    v_mfma_f32_16x16x32_bf16 v[88:91], v[56:59], v[188:191], v[88:91]
    s_waitcnt lgkmcnt(0)
    v_lshlrev_b32 v30, 16, v203
    v_and_b32 v31, 0xffff0000, v203
    v_mul_f32 v118, v30, v20
    v_mul_f32 v119, v31, v20
    v_mfma_f32_16x16x32_bf16 v[84:87], v[60:63], v[184:187], v[84:87]
    v_mfma_f32_16x16x32_bf16 v[92:95], v[60:63], v[188:191], v[92:95]
    v_lshlrev_b32 v30, 16, v204
    v_and_b32 v31, 0xffff0000, v204
    v_mul_f32 v120, v30, v21
    v_mul_f32 v121, v31, v21
    s_nop 3
    v_cvt_pk_bf16_f32 v224, v64, v65
    v_cvt_pk_bf16_f32 v225, v66, v67
    v_cvt_pk_bf16_f32 v226, v68, v69
    v_cvt_pk_bf16_f32 v227, v70, v71
    v_cvt_pk_bf16_f32 v228, v72, v73
    v_cvt_pk_bf16_f32 v229, v74, v75
    v_cvt_pk_bf16_f32 v230, v76, v77
    v_cvt_pk_bf16_f32 v231, v78, v79
    v_cvt_pk_bf16_f32 v232, v80, v81
    v_cvt_pk_bf16_f32 v233, v82, v83
    v_cvt_pk_bf16_f32 v234, v84, v85
    v_cvt_pk_bf16_f32 v235, v86, v87
    v_cvt_pk_bf16_f32 v236, v88, v89
    v_cvt_pk_bf16_f32 v237, v90, v91
    v_cvt_pk_bf16_f32 v238, v92, v93
    v_cvt_pk_bf16_f32 v239, v94, v95
    v_add3_u32 v11, v224, v225, s55
    v_add3_u32 v11, v11, v226, v227
    v_add3_u32 v11, v11, v228, v229
    v_add3_u32 v11, v11, v230, v231
    v_add3_u32 v11, v11, v232, v233
    v_add3_u32 v11, v11, v234, v235
    v_add3_u32 v11, v11, v236, v237
    v_add3_u32 v11, v11, v238, v239
    v_cmp_gt_u32 vcc, 13, v4
    s_cbranch_vccnz Ls_117
Lb_118:
    ds_read_b64_tr_b16 v[32:33], v14 offset:49152
    ds_read_b64_tr_b16 v[34:35], v14 offset:51200
    ds_read_b64_tr_b16 v[36:37], v15 offset:49152
    ds_read_b64_tr_b16 v[38:39], v15 offset:51200
    ds_read_b32 v4, v1 offset:2048
    ds_read_b64_tr_b16 v[40:41], v16 offset:49152
    ds_read_b64_tr_b16 v[42:43], v16 offset:51200
    ds_read_b64_tr_b16 v[44:45], v17 offset:49152
    ds_read_b64_tr_b16 v[46:47], v17 offset:51200
    ds_read_b64_tr_b16 v[48:49], v14 offset:53248
    ds_read_b64_tr_b16 v[50:51], v14 offset:55296
    s_waitcnt lgkmcnt(9)
    v_mfma_f32_16x16x32_bf16 v[64:67], v[32:35], v[128:131], 0
    ds_read_b64_tr_b16 v[52:53], v15 offset:53248
    ds_read_b64_tr_b16 v[54:55], v15 offset:55296
    v_mfma_f32_16x16x32_bf16 v[72:75], v[32:35], v[132:135], 0
    s_waitcnt lgkmcnt(6)
    s_add_u32 m0, s0, 3988
    s_nop 0
    global_load_lds_dword v7, s[16:17] offset:108
    v_lshlrev_b32 v30, 16, v205
    v_and_b32 v31, 0xffff0000, v205
    v_mul_f32 v122, v30, v21
    v_mfma_f32_16x16x32_bf16 v[68:71], v[36:39], v[128:131], 0
    ds_read_b64_tr_b16 v[56:57], v16 offset:53248
    ds_read_b64_tr_b16 v[58:59], v16 offset:55296
    v_mfma_f32_16x16x32_bf16 v[76:79], v[36:39], v[132:135], 0
    v_mul_f32 v123, v31, v21
    v_lshlrev_b32 v30, 16, v206
    v_and_b32 v31, 0xffff0000, v206
    v_mul_f32 v124, v30, v21
    v_mfma_f32_16x16x32_bf16 v[80:83], v[40:43], v[128:131], 0
    ds_read_b64_tr_b16 v[60:61], v17 offset:53248
    ds_read_b64_tr_b16 v[62:63], v17 offset:55296
    v_mfma_f32_16x16x32_bf16 v[88:91], v[40:43], v[132:135], 0
    s_waitcnt lgkmcnt(6)
    v_cmp_gt_u32 vcc, 14, v4
    v_mul_f32 v125, v31, v21
    v_lshlrev_b32 v30, 16, v207
    v_and_b32 v31, 0xffff0000, v207
    v_mul_f32 v126, v30, v21
    s_cbranch_vccnz Ls_119
Lb_120:
    v_mfma_f32_16x16x32_bf16 v[84:87], v[44:47], v[128:131], 0
    ds_read_b64_tr_b16 v[32:33], v14 offset:57344
    ds_read_b64_tr_b16 v[34:35], v14 offset:59392
    v_mfma_f32_16x16x32_bf16 v[92:95], v[44:47], v[132:135], 0
    v_mul_f32 v127, v31, v21
    v_mfma_f32_16x16x32_bf16 v[64:67], v[48:51], v[136:139], v[64:67]
    ds_read_b64_tr_b16 v[36:37], v15 offset:57344
    ds_read_b64_tr_b16 v[38:39], v15 offset:59392
    v_mfma_f32_16x16x32_bf16 v[72:75], v[48:51], v[140:143], v[72:75]
    s_waitcnt lgkmcnt(6)
    v_mfma_f32_16x16x32_bf16 v[68:71], v[52:55], v[136:139], v[68:71]
    ds_read_b32 v4, v1 offset:2048
    ds_read_b64_tr_b16 v[40:41], v16 offset:57344
    ds_read_b64_tr_b16 v[42:43], v16 offset:59392
    v_mfma_f32_16x16x32_bf16 v[76:79], v[52:55], v[140:143], v[76:79]
    v_mfma_f32_16x16x32_bf16 v[80:83], v[56:59], v[136:139], v[80:83]
    ds_read_b64_tr_b16 v[44:45], v17 offset:57344
    ds_read_b64_tr_b16 v[46:47], v17 offset:59392
    v_mfma_f32_16x16x32_bf16 v[88:91], v[56:59], v[140:143], v[88:91]
    s_waitcnt lgkmcnt(7)
    v_mfma_f32_16x16x32_bf16 v[84:87], v[60:63], v[136:139], v[84:87]
    ds_read_b64_tr_b16 v[48:49], v14 offset:61440
    ds_read_b64_tr_b16 v[50:51], v14 offset:63488
    v_mfma_f32_16x16x32_bf16 v[92:95], v[60:63], v[140:143], v[92:95]
    v_mfma_f32_16x16x32_bf16 v[64:67], v[32:35], v[144:147], v[64:67]
    ds_read_b64_tr_b16 v[52:53], v15 offset:61440
    ds_read_b64_tr_b16 v[54:55], v15 offset:63488
    v_mfma_f32_16x16x32_bf16 v[72:75], v[32:35], v[148:151], v[72:75]
    s_waitcnt lgkmcnt(6)
    v_mfma_f32_16x16x32_bf16 v[68:71], v[36:39], v[144:147], v[68:71]
    ds_read_b64_tr_b16 v[56:57], v16 offset:61440
    ds_read_b64_tr_b16 v[58:59], v16 offset:63488
    v_mfma_f32_16x16x32_bf16 v[76:79], v[36:39], v[148:151], v[76:79]
    v_mfma_f32_16x16x32_bf16 v[80:83], v[40:43], v[144:147], v[80:83]
    ds_read_b64_tr_b16 v[60:61], v17 offset:61440
    ds_read_b64_tr_b16 v[62:63], v17 offset:63488
    v_mfma_f32_16x16x32_bf16 v[88:91], v[40:43], v[148:151], v[88:91]
    s_waitcnt lgkmcnt(6)
    s_waitcnt vmcnt(1)
    v_add3_u32 v29, v208, v209, s54
    v_add3_u32 v29, v29, v210, v211
    v_add3_u32 v29, v29, v212, v213
    v_add3_u32 v29, v29, v214, v215
    v_add3_u32 v29, v29, v216, v217
    v_add3_u32 v29, v29, v218, v219
    v_add3_u32 v29, v29, v220, v221
    v_add3_u32 v29, v29, v222, v223
    v_cmp_ne_u32 vcc, v29, v13
    s_cbranch_vccnz Ls_121
Lb_122:
    buffer_store_dwordx4 v[224:227], v5, s[32:35], s69 offen offset:0
    buffer_store_dwordx4 v[228:231], v5, s[32:35], s69 offen offset:1024
    buffer_store_dwordx4 v[232:235], v5, s[32:35], s69 offen offset:2048
    buffer_store_dwordx4 v[236:239], v5, s[32:35], s69 offen offset:3072
    buffer_store_dword v11, v23, s[32:35], s47 offen
    s_cmp_lg_u32 s30, 0
    s_cbranch_scc1 Ls_125
Lb_126:
    v_cmp_gt_u32 vcc, 15, v4
    v_add_u32 v14, 0xffff0000, v14
    v_add_u32 v15, 0xffff0000, v15
    v_add_u32 v16, 0xffff0000, v16
    v_add_u32 v17, 0xffff0000, v17
    s_cbranch_vccnz Ls_127
Lb_128:
    v_mfma_f32_16x16x32_bf16 v[84:87], v[44:47], v[144:147], v[84:87]
    ds_read_b64_tr_b16 v[32:33], v14 offset:16384
    ds_read_b64_tr_b16 v[34:35], v14 offset:18432
    v_mfma_f32_16x16x32_bf16 v[92:95], v[44:47], v[148:151], v[92:95]
    v_lshlrev_b32 v30, 16, v208
    v_and_b32 v31, 0xffff0000, v208
    v_fmac_f32 v96, v30, v24
    v_fmac_f32 v97, v31, v24
    v_lshlrev_b32 v30, 16, v209
    v_and_b32 v31, 0xffff0000, v209
    v_fmac_f32 v98, v30, v24
    v_fmac_f32 v99, v31, v24
    v_mfma_f32_16x16x32_bf16 v[64:67], v[48:51], v[152:155], v[64:67]
    ds_read_b32 v0, v1 offset:4096
    ds_read_b64_tr_b16 v[36:37], v15 offset:16384
    ds_read_b64_tr_b16 v[38:39], v15 offset:18432
    v_mfma_f32_16x16x32_bf16 v[72:75], v[48:51], v[156:159], v[72:75]
    s_waitcnt lgkmcnt(7)
    v_lshlrev_b32 v30, 16, v210
    v_and_b32 v31, 0xffff0000, v210
    v_fmac_f32 v100, v30, v24
    v_fmac_f32 v101, v31, v24
    v_lshlrev_b32 v30, 16, v211
    v_and_b32 v31, 0xffff0000, v211
    v_fmac_f32 v102, v30, v24
    v_fmac_f32 v103, v31, v24
    v_mfma_f32_16x16x32_bf16 v[68:71], v[52:55], v[152:155], v[68:71]
    ds_read_b32 v4, v1 offset:2048
    ds_read_b64_tr_b16 v[40:41], v16 offset:16384
    ds_read_b64_tr_b16 v[42:43], v16 offset:18432
    v_mfma_f32_16x16x32_bf16 v[76:79], v[52:55], v[156:159], v[76:79]
    v_lshlrev_b32 v30, 16, v212
    v_and_b32 v31, 0xffff0000, v212
    v_fmac_f32 v104, v30, v25
    v_fmac_f32 v105, v31, v25
    v_lshlrev_b32 v30, 16, v213
    v_and_b32 v31, 0xffff0000, v213
    v_fmac_f32 v106, v30, v25
    v_fmac_f32 v107, v31, v25
    v_mfma_f32_16x16x32_bf16 v[80:83], v[56:59], v[152:155], v[80:83]
    ds_read_b64_tr_b16 v[44:45], v17 offset:16384
    ds_read_b64_tr_b16 v[46:47], v17 offset:18432
    v_mfma_f32_16x16x32_bf16 v[88:91], v[56:59], v[156:159], v[88:91]
    s_waitcnt lgkmcnt(8)
    v_lshlrev_b32 v30, 16, v214
    v_and_b32 v31, 0xffff0000, v214
    v_fmac_f32 v108, v30, v25
    v_fmac_f32 v109, v31, v25
    v_lshlrev_b32 v30, 16, v215
    v_and_b32 v31, 0xffff0000, v215
    v_fmac_f32 v110, v30, v25
    v_fmac_f32 v111, v31, v25
    v_mfma_f32_16x16x32_bf16 v[84:87], v[60:63], v[152:155], v[84:87]
    ds_read_b64_tr_b16 v[48:49], v14 offset:20480
    ds_read_b64_tr_b16 v[50:51], v14 offset:22528
    v_mfma_f32_16x16x32_bf16 v[92:95], v[60:63], v[156:159], v[92:95]
    v_lshlrev_b32 v30, 16, v216
    v_and_b32 v31, 0xffff0000, v216
    v_fmac_f32 v112, v30, v24
    v_fmac_f32 v113, v31, v24
    v_lshlrev_b32 v30, 16, v217
    v_and_b32 v31, 0xffff0000, v217
    v_fmac_f32 v114, v30, v24
    v_fmac_f32 v115, v31, v24
    v_mfma_f32_16x16x32_bf16 v[64:67], v[32:35], v[160:163], v[64:67]
    ds_read_b64_tr_b16 v[52:53], v15 offset:20480
    ds_read_b64_tr_b16 v[54:55], v15 offset:22528
    v_mfma_f32_16x16x32_bf16 v[72:75], v[32:35], v[164:167], v[72:75]
    s_waitcnt lgkmcnt(6)
    v_lshlrev_b32 v30, 16, v218
    v_and_b32 v31, 0xffff0000, v218
    v_fmac_f32 v116, v30, v24
    v_fmac_f32 v117, v31, v24
    v_lshlrev_b32 v30, 16, v219
    v_and_b32 v31, 0xffff0000, v219
    v_fmac_f32 v118, v30, v24
    v_fmac_f32 v119, v31, v24
    v_mfma_f32_16x16x32_bf16 v[68:71], v[36:39], v[160:163], v[68:71]
    ds_read_b64_tr_b16 v[56:57], v16 offset:20480
    ds_read_b64_tr_b16 v[58:59], v16 offset:22528
    v_mfma_f32_16x16x32_bf16 v[76:79], v[36:39], v[164:167], v[76:79]
    v_lshlrev_b32 v30, 16, v220
    v_and_b32 v31, 0xffff0000, v220
    v_fmac_f32 v120, v30, v25
    v_fmac_f32 v121, v31, v25
    v_lshlrev_b32 v30, 16, v221
    v_and_b32 v31, 0xffff0000, v221
    v_fmac_f32 v122, v30, v25
    v_fmac_f32 v123, v31, v25
    v_mfma_f32_16x16x32_bf16 v[80:83], v[40:43], v[160:163], v[80:83]
    ds_read_b64_tr_b16 v[60:61], v17 offset:20480
    ds_read_b64_tr_b16 v[62:63], v17 offset:22528
    v_mfma_f32_16x16x32_bf16 v[88:91], v[40:43], v[164:167], v[88:91]
    s_waitcnt lgkmcnt(6)
    v_lshlrev_b32 v30, 16, v222
    v_and_b32 v31, 0xffff0000, v222
    v_fmac_f32 v124, v30, v25
    v_fmac_f32 v125, v31, v25
    v_lshlrev_b32 v30, 16, v223
    v_and_b32 v31, 0xffff0000, v223
    v_fmac_f32 v126, v30, v25
    v_fmac_f32 v127, v31, v25
    v_cmp_gt_u32 vcc, 27, v0
    s_cbranch_vccnz Ls_129
Lb_130:
    v_cmp_gt_u32 vcc, 16, v4
    s_cbranch_vccnz Ls_131
Lb_132:
    v_mfma_f32_16x16x32_bf16 v[84:87], v[44:47], v[160:163], v[84:87]
    ds_read_b64_tr_b16 v[32:33], v14 offset:24576
    ds_read_b64_tr_b16 v[34:35], v14 offset:26624
    v_mfma_f32_16x16x32_bf16 v[92:95], v[44:47], v[164:167], v[92:95]
    v_mfma_f32_16x16x32_bf16 v[64:67], v[48:51], v[168:171], v[64:67]
    ds_read_b64_tr_b16 v[36:37], v15 offset:24576
    ds_read_b64_tr_b16 v[38:39], v15 offset:26624
    v_mfma_f32_16x16x32_bf16 v[72:75], v[48:51], v[172:175], v[72:75]
    s_waitcnt lgkmcnt(6)
    v_mfma_f32_16x16x32_bf16 v[68:71], v[52:55], v[168:171], v[68:71]
    ds_read_b64_tr_b16 v[40:41], v16 offset:24576
    ds_read_b64_tr_b16 v[42:43], v16 offset:26624
    v_mfma_f32_16x16x32_bf16 v[76:79], v[52:55], v[172:175], v[76:79]
    v_mfma_f32_16x16x32_bf16 v[80:83], v[56:59], v[168:171], v[80:83]
    ds_read_b64_tr_b16 v[44:45], v17 offset:24576
    ds_read_b64_tr_b16 v[46:47], v17 offset:26624
    v_mfma_f32_16x16x32_bf16 v[88:91], v[56:59], v[172:175], v[88:91]
    s_waitcnt lgkmcnt(6)
    s_cmp_lg_u32 s30, 0
    s_cbranch_scc1 Ls_133
Lb_134:
    buffer_load_dwordx4 v[240:243], v5, s[32:35], s66 offen offset:0 sc1
    buffer_load_dwordx4 v[244:247], v5, s[32:35], s66 offen offset:1024 sc1
    buffer_load_dwordx4 v[248:251], v5, s[32:35], s66 offen offset:2048 sc1
    buffer_load_dwordx4 v[252:255], v5, s[32:35], s66 offen offset:3072 sc1
    buffer_load_dword v12, v23, s[32:35], s44 offen sc1
    v_mfma_f32_16x16x32_bf16 v[84:87], v[60:63], v[168:171], v[84:87]
    ds_read_b64_tr_b16 v[48:49], v14 offset:28672
    ds_read_b64_tr_b16 v[50:51], v14 offset:30720
    v_mfma_f32_16x16x32_bf16 v[92:95], v[60:63], v[172:175], v[92:95]
    v_mfma_f32_16x16x32_bf16 v[64:67], v[32:35], v[176:179], v[64:67]
    ds_read_b64_tr_b16 v[52:53], v15 offset:28672
    ds_read_b64_tr_b16 v[54:55], v15 offset:30720
    v_mfma_f32_16x16x32_bf16 v[72:75], v[32:35], v[180:183], v[72:75]
    s_waitcnt lgkmcnt(6)
    v_mfma_f32_16x16x32_bf16 v[68:71], v[36:39], v[176:179], v[68:71]
    ds_read_b64_tr_b16 v[56:57], v16 offset:28672
    ds_read_b64_tr_b16 v[58:59], v16 offset:30720
    v_mfma_f32_16x16x32_bf16 v[76:79], v[36:39], v[180:183], v[76:79]
    v_mfma_f32_16x16x32_bf16 v[80:83], v[40:43], v[176:179], v[80:83]
    ds_read_b64_tr_b16 v[60:61], v17 offset:28672
    ds_read_b64_tr_b16 v[62:63], v17 offset:30720
    v_mfma_f32_16x16x32_bf16 v[88:91], v[40:43], v[180:183], v[88:91]
    s_waitcnt lgkmcnt(6)
    v_mfma_f32_16x16x32_bf16 v[84:87], v[44:47], v[176:179], v[84:87]
    v_mfma_f32_16x16x32_bf16 v[92:95], v[44:47], v[180:183], v[92:95]
    v_mfma_f32_16x16x32_bf16 v[64:67], v[48:51], v[184:187], v[64:67]
    v_mfma_f32_16x16x32_bf16 v[72:75], v[48:51], v[188:191], v[72:75]
    s_waitcnt lgkmcnt(2)
    v_mfma_f32_16x16x32_bf16 v[68:71], v[52:55], v[184:187], v[68:71]
    v_mfma_f32_16x16x32_bf16 v[76:79], v[52:55], v[188:191], v[76:79]
    v_mfma_f32_16x16x32_bf16 v[80:83], v[56:59], v[184:187], v[80:83]
    v_mfma_f32_16x16x32_bf16 v[88:91], v[56:59], v[188:191], v[88:91]
    s_waitcnt lgkmcnt(0)
    v_mfma_f32_16x16x32_bf16 v[84:87], v[60:63], v[184:187], v[84:87]
    v_mfma_f32_16x16x32_bf16 v[92:95], v[60:63], v[188:191], v[92:95]
    s_nop 3
    v_pk_fma_f32 v[96:97], v[64:65], v[18:19], v[96:97] op_sel:[0,0,0] op_sel_hi:[1,0,1]
    v_pk_fma_f32 v[98:99], v[66:67], v[18:19], v[98:99] op_sel:[0,0,0] op_sel_hi:[1,0,1]
    v_pk_fma_f32 v[100:101], v[68:69], v[18:19], v[100:101] op_sel:[0,0,0] op_sel_hi:[1,0,1]
    v_pk_fma_f32 v[102:103], v[70:71], v[18:19], v[102:103] op_sel:[0,0,0] op_sel_hi:[1,0,1]
    v_pk_fma_f32 v[104:105], v[72:73], v[18:19], v[104:105] op_sel:[0,1,0] op_sel_hi:[1,1,1]
    v_pk_fma_f32 v[106:107], v[74:75], v[18:19], v[106:107] op_sel:[0,1,0] op_sel_hi:[1,1,1]
    v_pk_fma_f32 v[108:109], v[76:77], v[18:19], v[108:109] op_sel:[0,1,0] op_sel_hi:[1,1,1]
    v_pk_fma_f32 v[110:111], v[78:79], v[18:19], v[110:111] op_sel:[0,1,0] op_sel_hi:[1,1,1]
    v_pk_fma_f32 v[112:113], v[80:81], v[18:19], v[112:113] op_sel:[0,0,0] op_sel_hi:[1,0,1]
    v_pk_fma_f32 v[114:115], v[82:83], v[18:19], v[114:115] op_sel:[0,0,0] op_sel_hi:[1,0,1]
    v_pk_fma_f32 v[116:117], v[84:85], v[18:19], v[116:117] op_sel:[0,0,0] op_sel_hi:[1,0,1]
    v_pk_fma_f32 v[118:119], v[86:87], v[18:19], v[118:119] op_sel:[0,0,0] op_sel_hi:[1,0,1]
    v_pk_fma_f32 v[120:121], v[88:89], v[18:19], v[120:121] op_sel:[0,1,0] op_sel_hi:[1,1,1]
    v_pk_fma_f32 v[122:123], v[90:91], v[18:19], v[122:123] op_sel:[0,1,0] op_sel_hi:[1,1,1]
    v_pk_fma_f32 v[124:125], v[92:93], v[18:19], v[124:125] op_sel:[0,1,0] op_sel_hi:[1,1,1]
    v_pk_fma_f32 v[126:127], v[94:95], v[18:19], v[126:127] op_sel:[0,1,0] op_sel_hi:[1,1,1]
    s_waitcnt vmcnt(0)
    v_add3_u32 v29, v240, v241, s55
    v_add3_u32 v29, v29, v242, v243
    v_add3_u32 v29, v29, v244, v245
    v_add3_u32 v29, v29, v246, v247
    v_add3_u32 v29, v29, v248, v249
    v_add3_u32 v29, v29, v250, v251
    v_add3_u32 v29, v29, v252, v253
    v_add3_u32 v29, v29, v254, v255
    v_cmp_ne_u32 vcc, v29, v12
    s_cbranch_vccnz Ls_135
Lb_136:
    v_lshlrev_b32 v30, 16, v240
    v_and_b32 v31, 0xffff0000, v240
    v_pk_fma_f32 v[96:97], v[30:31], v[26:27], v[96:97] op_sel:[0,0,0] op_sel_hi:[1,0,1]
    v_lshlrev_b32 v30, 16, v241
    v_and_b32 v31, 0xffff0000, v241
    v_pk_fma_f32 v[98:99], v[30:31], v[26:27], v[98:99] op_sel:[0,0,0] op_sel_hi:[1,0,1]
    v_lshlrev_b32 v30, 16, v242
    v_and_b32 v31, 0xffff0000, v242
    v_pk_fma_f32 v[100:101], v[30:31], v[26:27], v[100:101] op_sel:[0,0,0] op_sel_hi:[1,0,1]
    v_lshlrev_b32 v30, 16, v243
    v_and_b32 v31, 0xffff0000, v243
    v_pk_fma_f32 v[102:103], v[30:31], v[26:27], v[102:103] op_sel:[0,0,0] op_sel_hi:[1,0,1]
    v_cvt_pk_bf16_f32 v224, v96, v97
    v_cvt_pk_bf16_f32 v225, v98, v99
    v_cvt_pk_bf16_f32 v226, v100, v101
    v_cvt_pk_bf16_f32 v227, v102, v103
    buffer_store_dwordx4 v[224:227], v5, s[32:35], s66 offen offset:0
    v_lshlrev_b32 v30, 16, v244
    v_and_b32 v31, 0xffff0000, v244
    v_pk_fma_f32 v[104:105], v[30:31], v[26:27], v[104:105] op_sel:[0,1,0] op_sel_hi:[1,1,1]
    v_lshlrev_b32 v30, 16, v245
    v_and_b32 v31, 0xffff0000, v245
    v_pk_fma_f32 v[106:107], v[30:31], v[26:27], v[106:107] op_sel:[0,1,0] op_sel_hi:[1,1,1]
    v_lshlrev_b32 v30, 16, v246
    v_and_b32 v31, 0xffff0000, v246
    v_pk_fma_f32 v[108:109], v[30:31], v[26:27], v[108:109] op_sel:[0,1,0] op_sel_hi:[1,1,1]
    v_lshlrev_b32 v30, 16, v247
    v_and_b32 v31, 0xffff0000, v247
    v_pk_fma_f32 v[110:111], v[30:31], v[26:27], v[110:111] op_sel:[0,1,0] op_sel_hi:[1,1,1]
    v_cvt_pk_bf16_f32 v228, v104, v105
    v_cvt_pk_bf16_f32 v229, v106, v107
    v_cvt_pk_bf16_f32 v230, v108, v109
    v_cvt_pk_bf16_f32 v231, v110, v111
    buffer_store_dwordx4 v[228:231], v5, s[32:35], s66 offen offset:1024
    v_lshlrev_b32 v30, 16, v248
    v_and_b32 v31, 0xffff0000, v248
    v_pk_fma_f32 v[112:113], v[30:31], v[26:27], v[112:113] op_sel:[0,0,0] op_sel_hi:[1,0,1]
    v_lshlrev_b32 v30, 16, v249
    v_and_b32 v31, 0xffff0000, v249
    v_pk_fma_f32 v[114:115], v[30:31], v[26:27], v[114:115] op_sel:[0,0,0] op_sel_hi:[1,0,1]
    v_lshlrev_b32 v30, 16, v250
    v_and_b32 v31, 0xffff0000, v250
    v_pk_fma_f32 v[116:117], v[30:31], v[26:27], v[116:117] op_sel:[0,0,0] op_sel_hi:[1,0,1]
    v_lshlrev_b32 v30, 16, v251
    v_and_b32 v31, 0xffff0000, v251
    v_pk_fma_f32 v[118:119], v[30:31], v[26:27], v[118:119] op_sel:[0,0,0] op_sel_hi:[1,0,1]
    v_cvt_pk_bf16_f32 v232, v112, v113
    v_cvt_pk_bf16_f32 v233, v114, v115
    v_cvt_pk_bf16_f32 v234, v116, v117
    v_cvt_pk_bf16_f32 v235, v118, v119
    buffer_store_dwordx4 v[232:235], v5, s[32:35], s66 offen offset:2048
    v_lshlrev_b32 v30, 16, v252
    v_and_b32 v31, 0xffff0000, v252
    v_pk_fma_f32 v[120:121], v[30:31], v[26:27], v[120:121] op_sel:[0,1,0] op_sel_hi:[1,1,1]
    v_lshlrev_b32 v30, 16, v253
    v_and_b32 v31, 0xffff0000, v253
    v_pk_fma_f32 v[122:123], v[30:31], v[26:27], v[122:123] op_sel:[0,1,0] op_sel_hi:[1,1,1]
    v_lshlrev_b32 v30, 16, v254
    v_and_b32 v31, 0xffff0000, v254
    v_pk_fma_f32 v[124:125], v[30:31], v[26:27], v[124:125] op_sel:[0,1,0] op_sel_hi:[1,1,1]
    v_lshlrev_b32 v30, 16, v255
    v_and_b32 v31, 0xffff0000, v255
    v_pk_fma_f32 v[126:127], v[30:31], v[26:27], v[126:127] op_sel:[0,1,0] op_sel_hi:[1,1,1]
    v_cvt_pk_bf16_f32 v236, v120, v121
    v_cvt_pk_bf16_f32 v237, v122, v123
    v_cvt_pk_bf16_f32 v238, v124, v125
    v_cvt_pk_bf16_f32 v239, v126, v127
    buffer_store_dwordx4 v[236:239], v5, s[32:35], s66 offen offset:3072
    s_lshl_b32 s50, s23, 12
    s_add_u32 s50, s50, 32768
    v_add_u32 v0, s50, v5
    ds_write_b128 v0, v[224:227] offset:0
    ds_write_b128 v0, v[228:231] offset:1024
    ds_write_b128 v0, v[232:235] offset:2048
    ds_write_b128 v0, v[236:239] offset:3072
    v_mov_b32 v3, 1
    ds_write_b32 v2, v3 offset:5120
    buffer_load_dword v8, v28, s[32:35], 0 offen offset:4 sc1
    s_or_b32 s60, s29, 4
    v_mov_b32 v31, s60
    s_waitcnt vmcnt(1)
    s_cmp_lg_u32 s30, 0
    s_cbranch_scc1 Ls_139
Lb_140:
    buffer_store_dword v31, off, s[32:35], s44 offset:644
    s_cmp_lg_u32 s30, 0
    s_cbranch_scc1 Ls_141
Lb_142:
    s_waitcnt vmcnt(1)
    v_and_b32 v8, 15, v8
    v_cmp_gt_u32 vcc, 4, v8
    s_add_u32 m0, s50, 16384
    s_bitcmp1_b32 vcc_lo, 1
    s_cbranch_scc0 Lg_143
Li_144:
    s_sub_u32 s28, s28, 1
    s_cbranch_scc1 Lx_145
    s_cmp_lg_u32 s30, 0
    s_cbranch_scc1 Ls_147
Lb_148:
    buffer_load_dword v8, v28, s[32:35], 0 offen offset:4 sc1
    s_waitcnt vmcnt(0)
    v_and_b32 v8, 15, v8
    v_cmp_gt_u32 vcc, 4, v8
    s_bitcmp1_b32 vcc_lo, 1
    s_cbranch_scc1 Li_144
Ld_146:
Lg_143:
    s_cmp_lg_u32 s30, 0
    s_cbranch_scc1 Ls_149
Lb_150:
    buffer_load_dwordx4 v5, s[32:35], s67 offen offset:0 sc1 lds
    buffer_load_dwordx4 v5, s[32:35], s67 offen offset:1024 sc1 lds
    buffer_load_dwordx4 v5, s[32:35], s67 offen offset:2048 sc1 lds
    buffer_load_dwordx4 v5, s[32:35], s67 offen offset:3072 sc1 lds
    s_add_u32 m0, s0, 3068
    s_nop 0
    global_load_lds_dword v7, s[16:17] offset:4
    s_add_u32 m0, s50, 32768
    s_bitcmp1_b32 vcc_lo, 2
    s_cbranch_scc0 Lg_151
Li_152:
    s_sub_u32 s28, s28, 1
    s_cbranch_scc1 Lx_153
    s_cmp_lg_u32 s30, 0
    s_cbranch_scc1 Ls_155
Lb_156:
    buffer_load_dword v8, v28, s[32:35], 0 offen offset:4 sc1
    s_waitcnt vmcnt(0)
    v_and_b32 v8, 15, v8
    v_cmp_gt_u32 vcc, 4, v8
    s_bitcmp1_b32 vcc_lo, 2
    s_cbranch_scc1 Li_152
Ld_154:
Lg_151:
    s_cmp_lg_u32 s30, 0
    s_cbranch_scc1 Ls_157
Lb_158:
    buffer_load_dwordx4 v5, s[32:35], s68 offen offset:0 sc1 lds
    buffer_load_dwordx4 v5, s[32:35], s68 offen offset:1024 sc1 lds
    buffer_load_dwordx4 v5, s[32:35], s68 offen offset:2048 sc1 lds
    buffer_load_dwordx4 v5, s[32:35], s68 offen offset:3072 sc1 lds
    s_add_u32 m0, s0, 3064
    s_nop 0
    global_load_lds_dword v7, s[16:17] offset:8
    s_add_u32 m0, s50, 49152
    s_bitcmp1_b32 vcc_lo, 3
    s_cbranch_scc0 Lg_159
Li_160:
    s_sub_u32 s28, s28, 1
    s_cbranch_scc1 Lx_161
    s_cmp_lg_u32 s30, 0
    s_cbranch_scc1 Ls_163
Lb_164:
    buffer_load_dword v8, v28, s[32:35], 0 offen offset:4 sc1
    s_waitcnt vmcnt(0)
    v_and_b32 v8, 15, v8
    v_cmp_gt_u32 vcc, 4, v8
    s_bitcmp1_b32 vcc_lo, 3
    s_cbranch_scc1 Li_160
Ld_162:
Lg_159:
    s_cmp_lg_u32 s30, 0
    s_cbranch_scc1 Ls_165
Lb_166:
    buffer_load_dwordx4 v5, s[32:35], s69 offen offset:0 sc1 lds
    buffer_load_dwordx4 v5, s[32:35], s69 offen offset:1024 sc1 lds
    buffer_load_dwordx4 v5, s[32:35], s69 offen offset:2048 sc1 lds
    buffer_load_dwordx4 v5, s[32:35], s69 offen offset:3072 sc1 lds
    s_add_u32 m0, s0, 3060
    s_nop 0
    global_load_lds_dword v7, s[16:17] offset:12
Lexit:
    s_endpgm
Ls_2:
    ds_read_b32 v4, v1 offset:0
    s_waitcnt lgkmcnt(0)
    v_cmp_gt_u32 vcc, 1, v4
    s_cbranch_vccz Lb_3
    s_sleep 1
    s_sub_u32 s28, s28, 1
    s_cbranch_scc0 Ls_2
    s_mov_b32 s28, 0
    s_branch Lb_3
Ls_4:
    s_waitcnt vmcnt(0)
    buffer_wbl2 sc1
    s_waitcnt vmcnt(0)
    s_branch Lb_5
Ls_6:
    ds_read_b32 v4, v1 offset:0
    s_waitcnt lgkmcnt(0)
    v_cmp_gt_u32 vcc, 2, v4
    s_cbranch_vccz Lb_7
    s_sub_u32 s28, s28, 1
    s_cbranch_scc0 Ls_6
    s_mov_b32 s28, 0
    s_branch Lb_7
Ls_8:
    ds_read_b32 v4, v1 offset:0
    s_waitcnt lgkmcnt(0)
    v_cmp_gt_u32 vcc, 3, v4
    s_cbranch_vccz Lb_9
    s_sub_u32 s28, s28, 1
    s_cbranch_scc0 Ls_8
    s_mov_b32 s28, 0
    s_branch Lb_9
Ls_10:
    ds_read_b32 v4, v1 offset:0
    s_waitcnt lgkmcnt(0)
    v_cmp_gt_u32 vcc, 4, v4
    s_cbranch_vccz Lb_11
    s_sub_u32 s28, s28, 1
    s_cbranch_scc0 Ls_10
    s_mov_b32 s28, 0
    s_branch Lb_11
Ls_12:
    ds_read_b32 v4, v1 offset:0
    s_waitcnt lgkmcnt(0)
    v_cmp_gt_u32 vcc, 5, v4
    s_cbranch_vccz Lb_13
    s_sub_u32 s28, s28, 1
    s_cbranch_scc0 Ls_12
    s_mov_b32 s28, 0
    s_branch Lb_13
Ls_14:
    ds_read_b32 v4, v1 offset:0
    s_waitcnt lgkmcnt(0)
    v_cmp_gt_u32 vcc, 6, v4
    s_cbranch_vccz Lb_15
    s_sub_u32 s28, s28, 1
    s_cbranch_scc0 Ls_14
    s_mov_b32 s28, 0
    s_branch Lb_15
Ls_17:
    s_add_u32 s43, s43, 1
    s_cmp_lt_u32 s43, 256
    s_cbranch_scc1 Lf_19
    s_waitcnt vmcnt(0)
    buffer_wbl2 sc1
    s_waitcnt vmcnt(0)
    buffer_inv sc1
    s_waitcnt vmcnt(0)
Lf_19:
    buffer_load_dwordx2 v[26:27], v28, s[32:35], 0 offen sc1
    s_waitcnt vmcnt(0)
    s_sub_u32 s28, s28, 1
    s_cbranch_scc0 Lc_16
    s_mov_b32 s28, 0
    s_branch Lb_18
Ls_20:
    ds_read_b32 v4, v1 offset:0
    s_waitcnt lgkmcnt(0)
    v_cmp_gt_u32 vcc, 7, v4
    s_cbranch_vccz Lb_21
    s_sub_u32 s28, s28, 1
    s_cbranch_scc0 Ls_20
    s_mov_b32 s28, 0
    s_branch Lb_21
Ls_22:
    s_waitcnt vmcnt(0)
    buffer_wbl2 sc1
    s_waitcnt vmcnt(0)
    s_branch Lb_23
Ls_24:
    buffer_inv sc1
    s_waitcnt vmcnt(0)
    s_branch Lb_25
Ls_26:
    buffer_inv sc1
    s_waitcnt vmcnt(0)
    s_branch Lb_27
Ls_28:
    buffer_inv sc1
    s_waitcnt vmcnt(0)
    s_branch Lb_29
Ls_30:
    ds_read_b32 v4, v1 offset:1024
    s_waitcnt lgkmcnt(0)
    v_cmp_gt_u32 vcc, 1, v4
    s_cbranch_vccz Lb_31
    s_sleep 1
    s_sub_u32 s28, s28, 1
    s_cbranch_scc0 Ls_30
    s_mov_b32 s28, 0
    s_branch Lb_31
Ls_34:
    buffer_inv sc1
    s_waitcnt vmcnt(0)
    s_branch Lb_35
Ls_32:
    s_cmp_lg_u32 s30, 0
    s_cbranch_scc1 Ls_34
Lb_35:
    buffer_load_dwordx4 v[80:83], v5, s[32:35], s67 offen offset:0 sc1
    buffer_load_dwordx4 v[84:87], v5, s[32:35], s67 offen offset:1024 sc1
    buffer_load_dwordx4 v[88:91], v5, s[32:35], s67 offen offset:2048 sc1
    buffer_load_dwordx4 v[92:95], v5, s[32:35], s67 offen offset:3072 sc1
    buffer_load_dword v25, v23, s[32:35], s45 offen sc1
    s_waitcnt vmcnt(0)
    v_add3_u32 v29, v80, v81, s52
    v_add3_u32 v29, v29, v82, v83
    v_add3_u32 v29, v29, v84, v85
    v_add3_u32 v29, v29, v86, v87
    v_add3_u32 v29, v29, v88, v89
    v_add3_u32 v29, v29, v90, v91
    v_add3_u32 v29, v29, v92, v93
    v_add3_u32 v29, v29, v94, v95
    v_cmp_ne_u32 vcc, v29, v25
    s_cbranch_vccz Lb_33
    s_sub_u32 s28, s28, 1
    s_cbranch_scc0 Ls_32
    s_mov_b32 s28, 0
    s_branch Lb_33
Ls_38:
    buffer_inv sc1
    s_waitcnt vmcnt(0)
    s_branch Lb_39
Ls_36:
    s_cmp_lg_u32 s30, 0
    s_cbranch_scc1 Ls_38
Lb_39:
    buffer_load_dwordx4 v[96:99], v5, s[32:35], s68 offen offset:0 sc1
    buffer_load_dwordx4 v[100:103], v5, s[32:35], s68 offen offset:1024 sc1
    buffer_load_dwordx4 v[104:107], v5, s[32:35], s68 offen offset:2048 sc1
    buffer_load_dwordx4 v[108:111], v5, s[32:35], s68 offen offset:3072 sc1
    buffer_load_dword v26, v23, s[32:35], s46 offen sc1
    s_waitcnt vmcnt(0)
    v_add3_u32 v29, v96, v97, s52
    v_add3_u32 v29, v29, v98, v99
    v_add3_u32 v29, v29, v100, v101
    v_add3_u32 v29, v29, v102, v103
    v_add3_u32 v29, v29, v104, v105
    v_add3_u32 v29, v29, v106, v107
    v_add3_u32 v29, v29, v108, v109
    v_add3_u32 v29, v29, v110, v111
    v_cmp_ne_u32 vcc, v29, v26
    s_cbranch_vccz Lb_37
    s_sub_u32 s28, s28, 1
    s_cbranch_scc0 Ls_36
    s_mov_b32 s28, 0
    s_branch Lb_37
Ls_40:
    ds_read_b32 v4, v1 offset:1024
    s_waitcnt lgkmcnt(0)
    v_cmp_gt_u32 vcc, 2, v4
    s_cbranch_vccz Lb_41
    s_sleep 1
    s_sub_u32 s28, s28, 1
    s_cbranch_scc0 Ls_40
    s_mov_b32 s28, 0
    s_branch Lb_41
Ls_44:
    buffer_inv sc1
    s_waitcnt vmcnt(0)
    s_branch Lb_45
Ls_42:
    s_cmp_lg_u32 s30, 0
    s_cbranch_scc1 Ls_44
Lb_45:
    buffer_load_dwordx4 v[112:115], v5, s[32:35], s69 offen offset:0 sc1
    buffer_load_dwordx4 v[116:119], v5, s[32:35], s69 offen offset:1024 sc1
    buffer_load_dwordx4 v[120:123], v5, s[32:35], s69 offen offset:2048 sc1
    buffer_load_dwordx4 v[124:127], v5, s[32:35], s69 offen offset:3072 sc1
    buffer_load_dword v27, v23, s[32:35], s47 offen sc1
    s_waitcnt vmcnt(0)
    v_add3_u32 v29, v112, v113, s52
    v_add3_u32 v29, v29, v114, v115
    v_add3_u32 v29, v29, v116, v117
    v_add3_u32 v29, v29, v118, v119
    v_add3_u32 v29, v29, v120, v121
    v_add3_u32 v29, v29, v122, v123
    v_add3_u32 v29, v29, v124, v125
    v_add3_u32 v29, v29, v126, v127
    v_cmp_ne_u32 vcc, v29, v27
    s_cbranch_vccz Lb_43
    s_sub_u32 s28, s28, 1
    s_cbranch_scc0 Ls_42
    s_mov_b32 s28, 0
    s_branch Lb_43
Ls_46:
    s_waitcnt vmcnt(0)
    buffer_wbl2 sc1
    s_waitcnt vmcnt(0)
    s_branch Lb_47
Ls_48:
    ds_read_b32 v4, v1 offset:1024
    s_waitcnt lgkmcnt(0)
    v_cmp_gt_u32 vcc, 3, v4
    s_cbranch_vccz Lb_49
    s_sleep 1
    s_sub_u32 s28, s28, 1
    s_cbranch_scc0 Ls_48
    s_mov_b32 s28, 0
    s_branch Lb_49
Ls_50:
    ds_read_b32 v4, v1 offset:1024
    s_waitcnt lgkmcnt(0)
    v_cmp_gt_u32 vcc, 4, v4
    s_cbranch_vccz Lb_51
    s_sleep 1
    s_sub_u32 s28, s28, 1
    s_cbranch_scc0 Ls_50
    s_mov_b32 s28, 0
    s_branch Lb_51
Ls_52:
    v_max_f32 v20, v208, v209
    v_max3_f32 v20, v20, v210, v211
    v_max3_f32 v20, v20, v212, v213
    v_max3_f32 v20, v20, v214, v215
    v_max_f32 v21, v216, v217
    v_max3_f32 v21, v21, v218, v219
    v_max3_f32 v21, v21, v220, v221
    v_max3_f32 v21, v21, v222, v223
    s_nop 1
    v_permlane32_swap_b32 v20, v21
    s_nop 1
    v_max_f32 v20, v20, v21
    v_mov_b32 v21, v20
    s_nop 1
    v_permlane16_swap_b32 v20, v21
    s_nop 1
    v_max_f32 v20, v20, v21
    v_max_f32 v20, 0, v20
    v_add_f32 v22, v22, v20
    v_mov_b32 v21, v20
    s_nop 1
    v_permlane32_swap_b32 v20, v21
    s_nop 1
    v_sub_f32 v208, v208, v20
    v_sub_f32 v209, v209, v20
    v_sub_f32 v210, v210, v20
    v_sub_f32 v211, v211, v20
    v_sub_f32 v212, v212, v20
    v_sub_f32 v213, v213, v20
    v_sub_f32 v214, v214, v20
    v_sub_f32 v215, v215, v20
    v_sub_f32 v216, v216, v21
    v_sub_f32 v217, v217, v21
    v_sub_f32 v218, v218, v21
    v_sub_f32 v219, v219, v21
    v_sub_f32 v220, v220, v21
    v_sub_f32 v221, v221, v21
    v_sub_f32 v222, v222, v21
    v_sub_f32 v223, v223, v21
    v_sub_f32 v224, v224, v20
    v_sub_f32 v225, v225, v20
    v_sub_f32 v226, v226, v20
    v_sub_f32 v227, v227, v20
    v_sub_f32 v228, v228, v20
    v_sub_f32 v229, v229, v20
    v_sub_f32 v230, v230, v20
    v_sub_f32 v231, v231, v20
    v_sub_f32 v232, v232, v21
    v_sub_f32 v233, v233, v21
    v_sub_f32 v234, v234, v21
    v_sub_f32 v235, v235, v21
    v_sub_f32 v236, v236, v21
    v_sub_f32 v237, v237, v21
    v_sub_f32 v238, v238, v21
    v_sub_f32 v239, v239, v21
    s_call_b64 s[48:49], Lrescale
    s_branch Lb_53
Ls_54:
    v_max_f32 v20, v224, v225
    v_max3_f32 v20, v20, v226, v227
    v_max3_f32 v20, v20, v228, v229
    v_max3_f32 v20, v20, v230, v231
    v_max_f32 v21, v232, v233
    v_max3_f32 v21, v21, v234, v235
    v_max3_f32 v21, v21, v236, v237
    v_max3_f32 v21, v21, v238, v239
    s_nop 1
    v_permlane32_swap_b32 v20, v21
    s_nop 1
    v_max_f32 v20, v20, v21
    v_mov_b32 v21, v20
    s_nop 1
    v_permlane16_swap_b32 v20, v21
    s_nop 1
    v_max_f32 v20, v20, v21
    v_max_f32 v20, 0, v20
    v_add_f32 v22, v22, v20
    v_mov_b32 v21, v20
    s_nop 1
    v_permlane32_swap_b32 v20, v21
    s_nop 1
    v_sub_f32 v224, v224, v20
    v_sub_f32 v225, v225, v20
    v_sub_f32 v226, v226, v20
    v_sub_f32 v227, v227, v20
    v_sub_f32 v228, v228, v20
    v_sub_f32 v229, v229, v20
    v_sub_f32 v230, v230, v20
    v_sub_f32 v231, v231, v20
    v_sub_f32 v232, v232, v21
    v_sub_f32 v233, v233, v21
    v_sub_f32 v234, v234, v21
    v_sub_f32 v235, v235, v21
    v_sub_f32 v236, v236, v21
    v_sub_f32 v237, v237, v21
    v_sub_f32 v238, v238, v21
    v_sub_f32 v239, v239, v21
    v_sub_f32 v192, v192, v20
    v_sub_f32 v193, v193, v20
    v_sub_f32 v194, v194, v20
    v_sub_f32 v195, v195, v20
    v_sub_f32 v196, v196, v20
    v_sub_f32 v197, v197, v20
    v_sub_f32 v198, v198, v20
    v_sub_f32 v199, v199, v20
    v_sub_f32 v200, v200, v21
    v_sub_f32 v201, v201, v21
    v_sub_f32 v202, v202, v21
    v_sub_f32 v203, v203, v21
    v_sub_f32 v204, v204, v21
    v_sub_f32 v205, v205, v21
    v_sub_f32 v206, v206, v21
    v_sub_f32 v207, v207, v21
    s_call_b64 s[48:49], Lrescale
    s_branch Lb_55
Ls_56:
    ds_read_b32 v4, v1 offset:1024
    s_waitcnt lgkmcnt(0)
    v_cmp_gt_u32 vcc, 5, v4
    s_cbranch_vccz Lb_57
    s_sleep 1
    s_sub_u32 s28, s28, 1
    s_cbranch_scc0 Ls_56
    s_mov_b32 s28, 0
    s_branch Lb_57
Ls_58:
    v_max_f32 v20, v192, v193
    v_max3_f32 v20, v20, v194, v195
    v_max3_f32 v20, v20, v196, v197
    v_max3_f32 v20, v20, v198, v199
    v_max_f32 v21, v200, v201
    v_max3_f32 v21, v21, v202, v203
    v_max3_f32 v21, v21, v204, v205
    v_max3_f32 v21, v21, v206, v207
    s_nop 1
    v_permlane32_swap_b32 v20, v21
    s_nop 1
    v_max_f32 v20, v20, v21
    v_mov_b32 v21, v20
    s_nop 1
    v_permlane16_swap_b32 v20, v21
    s_nop 1
    v_max_f32 v20, v20, v21
    v_max_f32 v20, 0, v20
    v_add_f32 v22, v22, v20
    v_mov_b32 v21, v20
    s_nop 1
    v_permlane32_swap_b32 v20, v21
    s_nop 1
    v_sub_f32 v192, v192, v20
    v_sub_f32 v193, v193, v20
    v_sub_f32 v194, v194, v20
    v_sub_f32 v195, v195, v20
    v_sub_f32 v196, v196, v20
    v_sub_f32 v197, v197, v20
    v_sub_f32 v198, v198, v20
    v_sub_f32 v199, v199, v20
    v_sub_f32 v200, v200, v21
    v_sub_f32 v201, v201, v21
    v_sub_f32 v202, v202, v21
    v_sub_f32 v203, v203, v21
    v_sub_f32 v204, v204, v21
    v_sub_f32 v205, v205, v21
    v_sub_f32 v206, v206, v21
    v_sub_f32 v207, v207, v21
    v_sub_f32 v208, v208, v20
    v_sub_f32 v209, v209, v20
    v_sub_f32 v210, v210, v20
    v_sub_f32 v211, v211, v20
    v_sub_f32 v212, v212, v20
    v_sub_f32 v213, v213, v20
    v_sub_f32 v214, v214, v20
    v_sub_f32 v215, v215, v20
    v_sub_f32 v216, v216, v21
    v_sub_f32 v217, v217, v21
    v_sub_f32 v218, v218, v21
    v_sub_f32 v219, v219, v21
    v_sub_f32 v220, v220, v21
    v_sub_f32 v221, v221, v21
    v_sub_f32 v222, v222, v21
    v_sub_f32 v223, v223, v21
    s_call_b64 s[48:49], Lrescale
    s_branch Lb_59
Ls_60:
    ds_read_b32 v4, v1 offset:1024
    s_waitcnt lgkmcnt(0)
    v_cmp_gt_u32 vcc, 6, v4
    s_cbranch_vccz Lb_61
    s_sleep 1
    s_sub_u32 s28, s28, 1
    s_cbranch_scc0 Ls_60
    s_mov_b32 s28, 0
    s_branch Lb_61
Ls_62:
    v_max_f32 v20, v208, v209
    v_max3_f32 v20, v20, v210, v211
    v_max3_f32 v20, v20, v212, v213
    v_max3_f32 v20, v20, v214, v215
    v_max_f32 v21, v216, v217
    v_max3_f32 v21, v21, v218, v219
    v_max3_f32 v21, v21, v220, v221
    v_max3_f32 v21, v21, v222, v223
    s_nop 1
    v_permlane32_swap_b32 v20, v21
    s_nop 1
    v_max_f32 v20, v20, v21
    v_mov_b32 v21, v20
    s_nop 1
    v_permlane16_swap_b32 v20, v21
    s_nop 1
    v_max_f32 v20, v20, v21
    v_max_f32 v20, 0, v20
    v_add_f32 v22, v22, v20
    v_mov_b32 v21, v20
    s_nop 1
    v_permlane32_swap_b32 v20, v21
    s_nop 1
    v_sub_f32 v208, v208, v20
    v_sub_f32 v209, v209, v20
    v_sub_f32 v210, v210, v20
    v_sub_f32 v211, v211, v20
    v_sub_f32 v212, v212, v20
    v_sub_f32 v213, v213, v20
    v_sub_f32 v214, v214, v20
    v_sub_f32 v215, v215, v20
    v_sub_f32 v216, v216, v21
    v_sub_f32 v217, v217, v21
    v_sub_f32 v218, v218, v21
    v_sub_f32 v219, v219, v21
    v_sub_f32 v220, v220, v21
    v_sub_f32 v221, v221, v21
    v_sub_f32 v222, v222, v21
    v_sub_f32 v223, v223, v21
    v_sub_f32 v224, v224, v20
    v_sub_f32 v225, v225, v20
    v_sub_f32 v226, v226, v20
    v_sub_f32 v227, v227, v20
    v_sub_f32 v228, v228, v20
    v_sub_f32 v229, v229, v20
    v_sub_f32 v230, v230, v20
    v_sub_f32 v231, v231, v20
    v_sub_f32 v232, v232, v21
    v_sub_f32 v233, v233, v21
    v_sub_f32 v234, v234, v21
    v_sub_f32 v235, v235, v21
    v_sub_f32 v236, v236, v21
    v_sub_f32 v237, v237, v21
    v_sub_f32 v238, v238, v21
    v_sub_f32 v239, v239, v21
    s_call_b64 s[48:49], Lrescale
    s_branch Lb_63
Ls_64:
    ds_read_b32 v4, v1 offset:1024
    s_waitcnt lgkmcnt(0)
    v_cmp_gt_u32 vcc, 7, v4
    s_cbranch_vccz Lb_65
    s_sleep 1
    s_sub_u32 s28, s28, 1
    s_cbranch_scc0 Ls_64
    s_mov_b32 s28, 0
    s_branch Lb_65
Ls_66:
    v_max_f32 v20, v224, v225
    v_max3_f32 v20, v20, v226, v227
    v_max3_f32 v20, v20, v228, v229
    v_max3_f32 v20, v20, v230, v231
    v_max_f32 v21, v232, v233
    v_max3_f32 v21, v21, v234, v235
    v_max3_f32 v21, v21, v236, v237
    v_max3_f32 v21, v21, v238, v239
    s_nop 1
    v_permlane32_swap_b32 v20, v21
    s_nop 1
    v_max_f32 v20, v20, v21
    v_mov_b32 v21, v20
    s_nop 1
    v_permlane16_swap_b32 v20, v21
    s_nop 1
    v_max_f32 v20, v20, v21
    v_max_f32 v20, 0, v20
    v_add_f32 v22, v22, v20
    v_mov_b32 v21, v20
    s_nop 1
    v_permlane32_swap_b32 v20, v21
    s_nop 1
    v_sub_f32 v224, v224, v20
    v_sub_f32 v225, v225, v20
    v_sub_f32 v226, v226, v20
    v_sub_f32 v227, v227, v20
    v_sub_f32 v228, v228, v20
    v_sub_f32 v229, v229, v20
    v_sub_f32 v230, v230, v20
    v_sub_f32 v231, v231, v20
    v_sub_f32 v232, v232, v21
    v_sub_f32 v233, v233, v21
    v_sub_f32 v234, v234, v21
    v_sub_f32 v235, v235, v21
    v_sub_f32 v236, v236, v21
    v_sub_f32 v237, v237, v21
    v_sub_f32 v238, v238, v21
    v_sub_f32 v239, v239, v21
    v_sub_f32 v192, v192, v20
    v_sub_f32 v193, v193, v20
    v_sub_f32 v194, v194, v20
    v_sub_f32 v195, v195, v20
    v_sub_f32 v196, v196, v20
    v_sub_f32 v197, v197, v20
    v_sub_f32 v198, v198, v20
    v_sub_f32 v199, v199, v20
    v_sub_f32 v200, v200, v21
    v_sub_f32 v201, v201, v21
    v_sub_f32 v202, v202, v21
    v_sub_f32 v203, v203, v21
    v_sub_f32 v204, v204, v21
    v_sub_f32 v205, v205, v21
    v_sub_f32 v206, v206, v21
    v_sub_f32 v207, v207, v21
    s_call_b64 s[48:49], Lrescale
    s_branch Lb_67
Ls_68:
    ds_read_b32 v4, v1 offset:1024
    s_waitcnt lgkmcnt(0)
    v_cmp_gt_u32 vcc, 8, v4
    s_cbranch_vccz Lb_69
    s_sleep 1
    s_sub_u32 s28, s28, 1
    s_cbranch_scc0 Ls_68
    s_mov_b32 s28, 0
    s_branch Lb_69
Ls_70:
    v_max_f32 v20, v192, v193
    v_max3_f32 v20, v20, v194, v195
    v_max3_f32 v20, v20, v196, v197
    v_max3_f32 v20, v20, v198, v199
    v_max_f32 v21, v200, v201
    v_max3_f32 v21, v21, v202, v203
    v_max3_f32 v21, v21, v204, v205
    v_max3_f32 v21, v21, v206, v207
    s_nop 1
    v_permlane32_swap_b32 v20, v21
    s_nop 1
    v_max_f32 v20, v20, v21
    v_mov_b32 v21, v20
    s_nop 1
    v_permlane16_swap_b32 v20, v21
    s_nop 1
    v_max_f32 v20, v20, v21
    v_max_f32 v20, 0, v20
    v_add_f32 v22, v22, v20
    v_mov_b32 v21, v20
    s_nop 1
    v_permlane32_swap_b32 v20, v21
    s_nop 1
    v_sub_f32 v192, v192, v20
    v_sub_f32 v193, v193, v20
    v_sub_f32 v194, v194, v20
    v_sub_f32 v195, v195, v20
    v_sub_f32 v196, v196, v20
    v_sub_f32 v197, v197, v20
    v_sub_f32 v198, v198, v20
    v_sub_f32 v199, v199, v20
    v_sub_f32 v200, v200, v21
    v_sub_f32 v201, v201, v21
    v_sub_f32 v202, v202, v21
    v_sub_f32 v203, v203, v21
    v_sub_f32 v204, v204, v21
    v_sub_f32 v205, v205, v21
    v_sub_f32 v206, v206, v21
    v_sub_f32 v207, v207, v21
    v_sub_f32 v208, v208, v20
    v_sub_f32 v209, v209, v20
    v_sub_f32 v210, v210, v20
    v_sub_f32 v211, v211, v20
    v_sub_f32 v212, v212, v20
    v_sub_f32 v213, v213, v20
    v_sub_f32 v214, v214, v20
    v_sub_f32 v215, v215, v20
    v_sub_f32 v216, v216, v21
    v_sub_f32 v217, v217, v21
    v_sub_f32 v218, v218, v21
    v_sub_f32 v219, v219, v21
    v_sub_f32 v220, v220, v21
    v_sub_f32 v221, v221, v21
    v_sub_f32 v222, v222, v21
    v_sub_f32 v223, v223, v21
    s_call_b64 s[48:49], Lrescale
    s_branch Lb_71
Lrescale:
    v_sub_f32 v240, v240, v20
    v_sub_f32 v241, v241, v20
    v_sub_f32 v242, v242, v20
    v_sub_f32 v243, v243, v20
    v_sub_f32 v244, v244, v21
    v_sub_f32 v245, v245, v21
    v_sub_f32 v246, v246, v21
    v_sub_f32 v247, v247, v21
    v_exp_f32 v20, -v20
    v_exp_f32 v21, -v21
    s_nop 0
    v_mul_f32 v248, v248, v20
    v_mul_f32 v249, v249, v20
    v_mul_f32 v250, v250, v20
    v_mul_f32 v251, v251, v20
    v_mul_f32 v252, v252, v21
    v_mul_f32 v253, v253, v21
    v_mul_f32 v254, v254, v21
    v_mul_f32 v255, v255, v21
    v_lshlrev_b32 v30, 16, v128
    v_and_b32 v31, 0xffff0000, v128
    v_mul_f32 v30, v30, v20
    v_mul_f32 v31, v31, v20
    v_cvt_pk_bf16_f32 v128, v30, v31
    v_lshlrev_b32 v30, 16, v129
    v_and_b32 v31, 0xffff0000, v129
    v_mul_f32 v30, v30, v20
    v_mul_f32 v31, v31, v20
    v_cvt_pk_bf16_f32 v129, v30, v31
    v_lshlrev_b32 v30, 16, v130
    v_and_b32 v31, 0xffff0000, v130
    v_mul_f32 v30, v30, v20
    v_mul_f32 v31, v31, v20
    v_cvt_pk_bf16_f32 v130, v30, v31
    v_lshlrev_b32 v30, 16, v131
    v_and_b32 v31, 0xffff0000, v131
    v_mul_f32 v30, v30, v20
    v_mul_f32 v31, v31, v20
    v_cvt_pk_bf16_f32 v131, v30, v31
    v_lshlrev_b32 v30, 16, v132
    v_and_b32 v31, 0xffff0000, v132
    v_mul_f32 v30, v30, v21
    v_mul_f32 v31, v31, v21
    v_cvt_pk_bf16_f32 v132, v30, v31
    v_lshlrev_b32 v30, 16, v133
    v_and_b32 v31, 0xffff0000, v133
    v_mul_f32 v30, v30, v21
    v_mul_f32 v31, v31, v21
    v_cvt_pk_bf16_f32 v133, v30, v31
    v_lshlrev_b32 v30, 16, v134
    v_and_b32 v31, 0xffff0000, v134
    v_mul_f32 v30, v30, v21
    v_mul_f32 v31, v31, v21
    v_cvt_pk_bf16_f32 v134, v30, v31
    v_lshlrev_b32 v30, 16, v135
    v_and_b32 v31, 0xffff0000, v135
    v_mul_f32 v30, v30, v21
    v_mul_f32 v31, v31, v21
    v_cvt_pk_bf16_f32 v135, v30, v31
    v_lshlrev_b32 v30, 16, v136
    v_and_b32 v31, 0xffff0000, v136
    v_mul_f32 v30, v30, v20
    v_mul_f32 v31, v31, v20
    v_cvt_pk_bf16_f32 v136, v30, v31
    v_lshlrev_b32 v30, 16, v137
    v_and_b32 v31, 0xffff0000, v137
    v_mul_f32 v30, v30, v20
    v_mul_f32 v31, v31, v20
    v_cvt_pk_bf16_f32 v137, v30, v31
    v_lshlrev_b32 v30, 16, v138
    v_and_b32 v31, 0xffff0000, v138
    v_mul_f32 v30, v30, v20
    v_mul_f32 v31, v31, v20
    v_cvt_pk_bf16_f32 v138, v30, v31
    v_lshlrev_b32 v30, 16, v139
    v_and_b32 v31, 0xffff0000, v139
    v_mul_f32 v30, v30, v20
    v_mul_f32 v31, v31, v20
    v_cvt_pk_bf16_f32 v139, v30, v31
    v_lshlrev_b32 v30, 16, v140
    v_and_b32 v31, 0xffff0000, v140
    v_mul_f32 v30, v30, v21
    v_mul_f32 v31, v31, v21
    v_cvt_pk_bf16_f32 v140, v30, v31
    v_lshlrev_b32 v30, 16, v141
    v_and_b32 v31, 0xffff0000, v141
    v_mul_f32 v30, v30, v21
    v_mul_f32 v31, v31, v21
    v_cvt_pk_bf16_f32 v141, v30, v31
    v_lshlrev_b32 v30, 16, v142
    v_and_b32 v31, 0xffff0000, v142
    v_mul_f32 v30, v30, v21
    v_mul_f32 v31, v31, v21
    v_cvt_pk_bf16_f32 v142, v30, v31
    v_lshlrev_b32 v30, 16, v143
    v_and_b32 v31, 0xffff0000, v143
    v_mul_f32 v30, v30, v21
    v_mul_f32 v31, v31, v21
    v_cvt_pk_bf16_f32 v143, v30, v31
    v_lshlrev_b32 v30, 16, v144
    v_and_b32 v31, 0xffff0000, v144
    v_mul_f32 v30, v30, v20
    v_mul_f32 v31, v31, v20
    v_cvt_pk_bf16_f32 v144, v30, v31
    v_lshlrev_b32 v30, 16, v145
    v_and_b32 v31, 0xffff0000, v145
    v_mul_f32 v30, v30, v20
    v_mul_f32 v31, v31, v20
    v_cvt_pk_bf16_f32 v145, v30, v31
    v_lshlrev_b32 v30, 16, v146
    v_and_b32 v31, 0xffff0000, v146
    v_mul_f32 v30, v30, v20
    v_mul_f32 v31, v31, v20
    v_cvt_pk_bf16_f32 v146, v30, v31
    v_lshlrev_b32 v30, 16, v147
    v_and_b32 v31, 0xffff0000, v147
    v_mul_f32 v30, v30, v20
    v_mul_f32 v31, v31, v20
    v_cvt_pk_bf16_f32 v147, v30, v31
    v_lshlrev_b32 v30, 16, v148
    v_and_b32 v31, 0xffff0000, v148
    v_mul_f32 v30, v30, v21
    v_mul_f32 v31, v31, v21
    v_cvt_pk_bf16_f32 v148, v30, v31
    v_lshlrev_b32 v30, 16, v149
    v_and_b32 v31, 0xffff0000, v149
    v_mul_f32 v30, v30, v21
    v_mul_f32 v31, v31, v21
    v_cvt_pk_bf16_f32 v149, v30, v31
    v_lshlrev_b32 v30, 16, v150
    v_and_b32 v31, 0xffff0000, v150
    v_mul_f32 v30, v30, v21
    v_mul_f32 v31, v31, v21
    v_cvt_pk_bf16_f32 v150, v30, v31
    v_lshlrev_b32 v30, 16, v151
    v_and_b32 v31, 0xffff0000, v151
    v_mul_f32 v30, v30, v21
    v_mul_f32 v31, v31, v21
    v_cvt_pk_bf16_f32 v151, v30, v31
    v_lshlrev_b32 v30, 16, v152
    v_and_b32 v31, 0xffff0000, v152
    v_mul_f32 v30, v30, v20
    v_mul_f32 v31, v31, v20
    v_cvt_pk_bf16_f32 v152, v30, v31
    v_lshlrev_b32 v30, 16, v153
    v_and_b32 v31, 0xffff0000, v153
    v_mul_f32 v30, v30, v20
    v_mul_f32 v31, v31, v20
    v_cvt_pk_bf16_f32 v153, v30, v31
    v_lshlrev_b32 v30, 16, v154
    v_and_b32 v31, 0xffff0000, v154
    v_mul_f32 v30, v30, v20
    v_mul_f32 v31, v31, v20
    v_cvt_pk_bf16_f32 v154, v30, v31
    v_lshlrev_b32 v30, 16, v155
    v_and_b32 v31, 0xffff0000, v155
    v_mul_f32 v30, v30, v20
    v_mul_f32 v31, v31, v20
    v_cvt_pk_bf16_f32 v155, v30, v31
    v_lshlrev_b32 v30, 16, v156
    v_and_b32 v31, 0xffff0000, v156
    v_mul_f32 v30, v30, v21
    v_mul_f32 v31, v31, v21
    v_cvt_pk_bf16_f32 v156, v30, v31
    v_lshlrev_b32 v30, 16, v157
    v_and_b32 v31, 0xffff0000, v157
    v_mul_f32 v30, v30, v21
    v_mul_f32 v31, v31, v21
    v_cvt_pk_bf16_f32 v157, v30, v31
    v_lshlrev_b32 v30, 16, v158
    v_and_b32 v31, 0xffff0000, v158
    v_mul_f32 v30, v30, v21
    v_mul_f32 v31, v31, v21
    v_cvt_pk_bf16_f32 v158, v30, v31
    v_lshlrev_b32 v30, 16, v159
    v_and_b32 v31, 0xffff0000, v159
    v_mul_f32 v30, v30, v21
    v_mul_f32 v31, v31, v21
    v_cvt_pk_bf16_f32 v159, v30, v31
    v_lshlrev_b32 v30, 16, v160
    v_and_b32 v31, 0xffff0000, v160
    v_mul_f32 v30, v30, v20
    v_mul_f32 v31, v31, v20
    v_cvt_pk_bf16_f32 v160, v30, v31
    v_lshlrev_b32 v30, 16, v161
    v_and_b32 v31, 0xffff0000, v161
    v_mul_f32 v30, v30, v20
    v_mul_f32 v31, v31, v20
    v_cvt_pk_bf16_f32 v161, v30, v31
    v_lshlrev_b32 v30, 16, v162
    v_and_b32 v31, 0xffff0000, v162
    v_mul_f32 v30, v30, v20
    v_mul_f32 v31, v31, v20
    v_cvt_pk_bf16_f32 v162, v30, v31
    v_lshlrev_b32 v30, 16, v163
    v_and_b32 v31, 0xffff0000, v163
    v_mul_f32 v30, v30, v20
    v_mul_f32 v31, v31, v20
    v_cvt_pk_bf16_f32 v163, v30, v31
    v_lshlrev_b32 v30, 16, v164
    v_and_b32 v31, 0xffff0000, v164
    v_mul_f32 v30, v30, v21
    v_mul_f32 v31, v31, v21
    v_cvt_pk_bf16_f32 v164, v30, v31
    v_lshlrev_b32 v30, 16, v165
    v_and_b32 v31, 0xffff0000, v165
    v_mul_f32 v30, v30, v21
    v_mul_f32 v31, v31, v21
    v_cvt_pk_bf16_f32 v165, v30, v31
    v_lshlrev_b32 v30, 16, v166
    v_and_b32 v31, 0xffff0000, v166
    v_mul_f32 v30, v30, v21
    v_mul_f32 v31, v31, v21
    v_cvt_pk_bf16_f32 v166, v30, v31
    v_lshlrev_b32 v30, 16, v167
    v_and_b32 v31, 0xffff0000, v167
    v_mul_f32 v30, v30, v21
    v_mul_f32 v31, v31, v21
    v_cvt_pk_bf16_f32 v167, v30, v31
    v_lshlrev_b32 v30, 16, v168
    v_and_b32 v31, 0xffff0000, v168
    v_mul_f32 v30, v30, v20
    v_mul_f32 v31, v31, v20
    v_cvt_pk_bf16_f32 v168, v30, v31
    v_lshlrev_b32 v30, 16, v169
    v_and_b32 v31, 0xffff0000, v169
    v_mul_f32 v30, v30, v20
    v_mul_f32 v31, v31, v20
    v_cvt_pk_bf16_f32 v169, v30, v31
    v_lshlrev_b32 v30, 16, v170
    v_and_b32 v31, 0xffff0000, v170
    v_mul_f32 v30, v30, v20
    v_mul_f32 v31, v31, v20
    v_cvt_pk_bf16_f32 v170, v30, v31
    v_lshlrev_b32 v30, 16, v171
    v_and_b32 v31, 0xffff0000, v171
    v_mul_f32 v30, v30, v20
    v_mul_f32 v31, v31, v20
    v_cvt_pk_bf16_f32 v171, v30, v31
    v_lshlrev_b32 v30, 16, v172
    v_and_b32 v31, 0xffff0000, v172
    v_mul_f32 v30, v30, v21
    v_mul_f32 v31, v31, v21
    v_cvt_pk_bf16_f32 v172, v30, v31
    v_lshlrev_b32 v30, 16, v173
    v_and_b32 v31, 0xffff0000, v173
    v_mul_f32 v30, v30, v21
    v_mul_f32 v31, v31, v21
    v_cvt_pk_bf16_f32 v173, v30, v31
    v_lshlrev_b32 v30, 16, v174
    v_and_b32 v31, 0xffff0000, v174
    v_mul_f32 v30, v30, v21
    v_mul_f32 v31, v31, v21
    v_cvt_pk_bf16_f32 v174, v30, v31
    v_lshlrev_b32 v30, 16, v175
    v_and_b32 v31, 0xffff0000, v175
    v_mul_f32 v30, v30, v21
    v_mul_f32 v31, v31, v21
    v_cvt_pk_bf16_f32 v175, v30, v31
    v_lshlrev_b32 v30, 16, v176
    v_and_b32 v31, 0xffff0000, v176
    v_mul_f32 v30, v30, v20
    v_mul_f32 v31, v31, v20
    v_cvt_pk_bf16_f32 v176, v30, v31
    v_lshlrev_b32 v30, 16, v177
    v_and_b32 v31, 0xffff0000, v177
    v_mul_f32 v30, v30, v20
    v_mul_f32 v31, v31, v20
    v_cvt_pk_bf16_f32 v177, v30, v31
    v_lshlrev_b32 v30, 16, v178
    v_and_b32 v31, 0xffff0000, v178
    v_mul_f32 v30, v30, v20
    v_mul_f32 v31, v31, v20
    v_cvt_pk_bf16_f32 v178, v30, v31
    v_lshlrev_b32 v30, 16, v179
    v_and_b32 v31, 0xffff0000, v179
    v_mul_f32 v30, v30, v20
    v_mul_f32 v31, v31, v20
    v_cvt_pk_bf16_f32 v179, v30, v31
    v_lshlrev_b32 v30, 16, v180
    v_and_b32 v31, 0xffff0000, v180
    v_mul_f32 v30, v30, v21
    v_mul_f32 v31, v31, v21
    v_cvt_pk_bf16_f32 v180, v30, v31
    v_lshlrev_b32 v30, 16, v181
    v_and_b32 v31, 0xffff0000, v181
    v_mul_f32 v30, v30, v21
    v_mul_f32 v31, v31, v21
    v_cvt_pk_bf16_f32 v181, v30, v31
    v_lshlrev_b32 v30, 16, v182
    v_and_b32 v31, 0xffff0000, v182
    v_mul_f32 v30, v30, v21
    v_mul_f32 v31, v31, v21
    v_cvt_pk_bf16_f32 v182, v30, v31
    v_lshlrev_b32 v30, 16, v183
    v_and_b32 v31, 0xffff0000, v183
    v_mul_f32 v30, v30, v21
    v_mul_f32 v31, v31, v21
    v_cvt_pk_bf16_f32 v183, v30, v31
    s_nop 1
    s_setpc_b64 s[48:49]
Ls_72:
    ds_read_b32 v4, v1 offset:2048
    s_waitcnt lgkmcnt(0)
    v_cmp_gt_u32 vcc, 1, v4
    s_cbranch_vccz Lb_73
    s_sleep 1
    s_sub_u32 s28, s28, 1
    s_cbranch_scc0 Ls_72
    s_mov_b32 s28, 0
    s_branch Lb_73
Ls_74:
    v_max_f32 v20, v208, v209
    v_max3_f32 v20, v20, v210, v211
    v_max3_f32 v20, v20, v212, v213
    v_max3_f32 v20, v20, v214, v215
    v_max_f32 v21, v216, v217
    v_max3_f32 v21, v21, v218, v219
    v_max3_f32 v21, v21, v220, v221
    v_max3_f32 v21, v21, v222, v223
    s_nop 1
    v_permlane32_swap_b32 v20, v21
    s_nop 1
    v_max_f32 v20, v20, v21
    v_mov_b32 v21, v20
    s_nop 1
    v_permlane16_swap_b32 v20, v21
    s_nop 1
    v_max_f32 v20, v20, v21
    v_max_f32 v20, 0, v20
    v_add_f32 v22, v22, v20
    v_mov_b32 v21, v20
    s_nop 1
    v_permlane32_swap_b32 v20, v21
    s_nop 1
    v_sub_f32 v208, v208, v20
    v_sub_f32 v209, v209, v20
    v_sub_f32 v210, v210, v20
    v_sub_f32 v211, v211, v20
    v_sub_f32 v212, v212, v20
    v_sub_f32 v213, v213, v20
    v_sub_f32 v214, v214, v20
    v_sub_f32 v215, v215, v20
    v_sub_f32 v216, v216, v21
    v_sub_f32 v217, v217, v21
    v_sub_f32 v218, v218, v21
    v_sub_f32 v219, v219, v21
    v_sub_f32 v220, v220, v21
    v_sub_f32 v221, v221, v21
    v_sub_f32 v222, v222, v21
    v_sub_f32 v223, v223, v21
    s_call_b64 s[48:49], Lrescale
    s_branch Lb_75
Ls_76:
    ds_read_b32 v4, v1 offset:2048
    s_waitcnt lgkmcnt(0)
    v_cmp_gt_u32 vcc, 2, v4
    s_cbranch_vccz Lb_77
    s_sleep 1
    s_sub_u32 s28, s28, 1
    s_cbranch_scc0 Ls_76
    s_mov_b32 s28, 0
    s_branch Lb_77
Ls_78:
    ds_read_b32 v4, v1 offset:2048
    s_waitcnt lgkmcnt(0)
    v_cmp_gt_u32 vcc, 3, v4
    s_cbranch_vccz Lb_79
    s_sleep 1
    s_sub_u32 s28, s28, 1
    s_cbranch_scc0 Ls_78
    s_mov_b32 s28, 0
    s_branch Lb_79
Ls_80:
    ds_read_b32 v4, v1 offset:2048
    s_waitcnt lgkmcnt(0)
    v_cmp_gt_u32 vcc, 4, v4
    s_cbranch_vccz Lb_81
    s_sleep 1
    s_sub_u32 s28, s28, 1
    s_cbranch_scc0 Ls_80
    s_mov_b32 s28, 0
    s_branch Lb_81
Ls_82:
    s_waitcnt vmcnt(0)
    buffer_wbl2 sc1
    s_waitcnt vmcnt(0)
    s_branch Lb_83
Ls_84:
    ds_read_b32 v4, v1 offset:2048
    s_waitcnt lgkmcnt(0)
    v_cmp_gt_u32 vcc, 5, v4
    s_cbranch_vccz Lb_85
    s_sleep 1
    s_sub_u32 s28, s28, 1
    s_cbranch_scc0 Ls_84
    s_mov_b32 s28, 0
    s_branch Lb_85
Ls_86:
    ds_read_b32 v4, v1 offset:2048
    s_waitcnt lgkmcnt(0)
    v_cmp_gt_u32 vcc, 6, v4
    s_cbranch_vccz Lb_87
    s_sleep 1
    s_sub_u32 s28, s28, 1
    s_cbranch_scc0 Ls_86
    s_mov_b32 s28, 0
    s_branch Lb_87
Ls_88:
    ds_read_b32 v4, v1 offset:2048
    s_waitcnt lgkmcnt(0)
    v_cmp_gt_u32 vcc, 7, v4
    s_cbranch_vccz Lb_89
    s_sleep 1
    s_sub_u32 s28, s28, 1
    s_cbranch_scc0 Ls_88
    s_mov_b32 s28, 0
    s_branch Lb_89
Ls_90:
    buffer_inv sc1
    s_waitcnt vmcnt(0)
    s_branch Lb_91
Ls_92:
    buffer_inv sc1
    s_waitcnt vmcnt(0)
    s_branch Lb_93
Ls_94:
    ds_read_b32 v4, v1 offset:2048
    s_waitcnt lgkmcnt(0)
    v_cmp_gt_u32 vcc, 8, v4
    s_cbranch_vccz Lb_95
    s_sleep 1
    s_sub_u32 s28, s28, 1
    s_cbranch_scc0 Ls_94
    s_mov_b32 s28, 0
    s_branch Lb_95
Ls_96:
    ds_read_b32 v4, v1 offset:2048
    s_waitcnt lgkmcnt(0)
    v_cmp_gt_u32 vcc, 9, v4
    s_cbranch_vccz Lb_97
    s_sleep 1
    s_sub_u32 s28, s28, 1
    s_cbranch_scc0 Ls_96
    s_mov_b32 s28, 0
    s_branch Lb_97
Ls_98:
    ds_read_b32 v4, v1 offset:2048
    s_waitcnt lgkmcnt(0)
    v_cmp_gt_u32 vcc, 10, v4
    s_cbranch_vccz Lb_99
    s_sleep 1
    s_sub_u32 s28, s28, 1
    s_cbranch_scc0 Ls_98
    s_mov_b32 s28, 0
    s_branch Lb_99
Ls_102:
    buffer_inv sc1
    s_waitcnt vmcnt(0)
    s_branch Lb_103
Ls_100:
    s_cmp_lg_u32 s30, 0
    s_cbranch_scc1 Ls_102
Lb_103:
    buffer_load_dwordx4 v[192:195], v5, s[32:35], s67 offen offset:0 sc1
    buffer_load_dwordx4 v[196:199], v5, s[32:35], s67 offen offset:1024 sc1
    buffer_load_dwordx4 v[200:203], v5, s[32:35], s67 offen offset:2048 sc1
    buffer_load_dwordx4 v[204:207], v5, s[32:35], s67 offen offset:3072 sc1
    buffer_load_dword v12, v23, s[32:35], s45 offen sc1
    s_waitcnt vmcnt(0)
    v_add3_u32 v29, v192, v193, s53
    v_add3_u32 v29, v29, v194, v195
    v_add3_u32 v29, v29, v196, v197
    v_add3_u32 v29, v29, v198, v199
    v_add3_u32 v29, v29, v200, v201
    v_add3_u32 v29, v29, v202, v203
    v_add3_u32 v29, v29, v204, v205
    v_add3_u32 v29, v29, v206, v207
    v_cmp_ne_u32 vcc, v29, v12
    s_cbranch_vccz Lb_101
    s_sub_u32 s28, s28, 1
    s_cbranch_scc0 Ls_100
    s_mov_b32 s28, 0
    s_branch Lb_101
Ls_104:
    s_waitcnt vmcnt(0)
    buffer_wbl2 sc1
    s_waitcnt vmcnt(0)
    s_branch Lb_105
Ls_109:
    buffer_inv sc1
    s_waitcnt vmcnt(0)
    s_branch Lb_110
Ls_107:
    s_cmp_lg_u32 s30, 0
    s_cbranch_scc1 Ls_109
Lb_110:
    buffer_load_dwordx3 v[240:242], v6, s[32:35], s45 offen offset:256 sc1
    buffer_load_dwordx3 v[244:246], v6, s[32:35], s46 offen offset:256 sc1
    buffer_load_dwordx3 v[248:250], v6, s[32:35], s47 offen offset:256 sc1
    s_waitcnt vmcnt(0)
    s_sub_u32 s28, s28, 1
    s_cbranch_scc0 Lv_106
    s_mov_b32 s28, 0
    s_branch Lb_108
Ls_111:
    ds_read_b32 v4, v1 offset:2048
    s_waitcnt lgkmcnt(0)
    v_cmp_gt_u32 vcc, 11, v4
    s_cbranch_vccz Lb_112
    s_sleep 1
    s_sub_u32 s28, s28, 1
    s_cbranch_scc0 Ls_111
    s_mov_b32 s28, 0
    s_branch Lb_112
Ls_113:
    buffer_inv sc1
    s_waitcnt vmcnt(0)
    s_branch Lb_114
Ls_115:
    ds_read_b32 v4, v1 offset:2048
    s_waitcnt lgkmcnt(0)
    v_cmp_gt_u32 vcc, 12, v4
    s_cbranch_vccz Lb_116
    s_sleep 1
    s_sub_u32 s28, s28, 1
    s_cbranch_scc0 Ls_115
    s_mov_b32 s28, 0
    s_branch Lb_116
Ls_117:
    ds_read_b32 v4, v1 offset:2048
    s_waitcnt lgkmcnt(0)
    v_cmp_gt_u32 vcc, 13, v4
    s_cbranch_vccz Lb_118
    s_sleep 1
    s_sub_u32 s28, s28, 1
    s_cbranch_scc0 Ls_117
    s_mov_b32 s28, 0
    s_branch Lb_118
Ls_119:
    ds_read_b32 v4, v1 offset:2048
    s_waitcnt lgkmcnt(0)
    v_cmp_gt_u32 vcc, 14, v4
    s_cbranch_vccz Lb_120
    s_sleep 1
    s_sub_u32 s28, s28, 1
    s_cbranch_scc0 Ls_119
    s_mov_b32 s28, 0
    s_branch Lb_120
Ls_123:
    buffer_inv sc1
    s_waitcnt vmcnt(0)
    s_branch Lb_124
Ls_121:
    s_cmp_lg_u32 s30, 0
    s_cbranch_scc1 Ls_123
Lb_124:
    buffer_load_dwordx4 v[208:211], v5, s[32:35], s69 offen offset:0 sc1
    buffer_load_dwordx4 v[212:215], v5, s[32:35], s69 offen offset:1024 sc1
    buffer_load_dwordx4 v[216:219], v5, s[32:35], s69 offen offset:2048 sc1
    buffer_load_dwordx4 v[220:223], v5, s[32:35], s69 offen offset:3072 sc1
    buffer_load_dword v13, v23, s[32:35], s47 offen sc1
    s_waitcnt vmcnt(0)
    v_add3_u32 v29, v208, v209, s54
    v_add3_u32 v29, v29, v210, v211
    v_add3_u32 v29, v29, v212, v213
    v_add3_u32 v29, v29, v214, v215
    v_add3_u32 v29, v29, v216, v217
    v_add3_u32 v29, v29, v218, v219
    v_add3_u32 v29, v29, v220, v221
    v_add3_u32 v29, v29, v222, v223
    v_cmp_ne_u32 vcc, v29, v13
    s_cbranch_vccz Lb_122
    s_sub_u32 s28, s28, 1
    s_cbranch_scc0 Ls_121
    s_mov_b32 s28, 0
    s_branch Lb_122
Ls_125:
    s_waitcnt vmcnt(0)
    buffer_wbl2 sc1
    s_waitcnt vmcnt(0)
    s_branch Lb_126
Ls_127:
    ds_read_b32 v4, v1 offset:2048
    s_waitcnt lgkmcnt(0)
    v_cmp_gt_u32 vcc, 15, v4
    s_cbranch_vccz Lb_128
    s_sleep 1
    s_sub_u32 s28, s28, 1
    s_cbranch_scc0 Ls_127
    s_mov_b32 s28, 0
    s_branch Lb_128
Ls_129:
    ds_read_b32 v0, v1 offset:4096
    s_waitcnt lgkmcnt(0)
    v_cmp_gt_u32 vcc, 27, v0
    s_cbranch_vccz Lb_130
    s_sleep 1
    s_sub_u32 s28, s28, 1
    s_cbranch_scc0 Ls_129
    s_mov_b32 s28, 0
    s_branch Lb_130
Ls_131:
    ds_read_b32 v4, v1 offset:2048
    s_waitcnt lgkmcnt(0)
    v_cmp_gt_u32 vcc, 16, v4
    s_cbranch_vccz Lb_132
    s_sub_u32 s28, s28, 1
    s_cbranch_scc0 Ls_131
    s_mov_b32 s28, 0
    s_branch Lb_132
Ls_133:
    buffer_inv sc1
    s_waitcnt vmcnt(0)
    s_branch Lb_134
Ls_137:
    buffer_inv sc1
    s_waitcnt vmcnt(0)
    s_branch Lb_138
Ls_135:
    s_cmp_lg_u32 s30, 0
    s_cbranch_scc1 Ls_137
Lb_138:
    buffer_load_dwordx4 v[240:243], v5, s[32:35], s66 offen offset:0 sc1
    buffer_load_dwordx4 v[244:247], v5, s[32:35], s66 offen offset:1024 sc1
    buffer_load_dwordx4 v[248:251], v5, s[32:35], s66 offen offset:2048 sc1
    buffer_load_dwordx4 v[252:255], v5, s[32:35], s66 offen offset:3072 sc1
    buffer_load_dword v12, v23, s[32:35], s44 offen sc1
    s_waitcnt vmcnt(0)
    v_add3_u32 v29, v240, v241, s55
    v_add3_u32 v29, v29, v242, v243
    v_add3_u32 v29, v29, v244, v245
    v_add3_u32 v29, v29, v246, v247
    v_add3_u32 v29, v29, v248, v249
    v_add3_u32 v29, v29, v250, v251
    v_add3_u32 v29, v29, v252, v253
    v_add3_u32 v29, v29, v254, v255
    v_cmp_ne_u32 vcc, v29, v12
    s_cbranch_vccz Lb_136
    s_sub_u32 s28, s28, 1
    s_cbranch_scc0 Ls_135
    s_mov_b32 s28, 0
    s_branch Lb_136
Ls_139:
    s_waitcnt vmcnt(0)
    buffer_wbl2 sc1
    s_waitcnt vmcnt(0)
    s_branch Lb_140
Ls_141:
    s_waitcnt vmcnt(0)
    buffer_wbl2 sc1
    s_waitcnt vmcnt(0)
    s_branch Lb_142
Ls_147:
    buffer_inv sc1
    s_waitcnt vmcnt(0)
    s_branch Lb_148
Lx_145:
    s_mov_b32 s28, 0
    s_branch Ld_146
Ls_149:
    buffer_inv sc1
    s_waitcnt vmcnt(0)
    s_branch Lb_150
Ls_155:
    buffer_inv sc1
    s_waitcnt vmcnt(0)
    s_branch Lb_156
Lx_153:
    s_mov_b32 s28, 0
    s_branch Ld_154
Ls_157:
    buffer_inv sc1
    s_waitcnt vmcnt(0)
    s_branch Lb_158
Ls_163:
    buffer_inv sc1
    s_waitcnt vmcnt(0)
    s_branch Lb_164
Lx_161:
    s_mov_b32 s28, 0
    s_branch Ld_162
Ls_165:
    buffer_inv sc1
    s_waitcnt vmcnt(0)
    s_branch Lb_166
.p2align 7
.type Ltable,@object
Ltable:
.long 0, 1, 2, 3, 4, 5, 6, 7, 8, 9, 10, 11, 12, 13, 14, 15, 16, 17, 18, 19, 20, 21, 22, 23, 24, 25, 26, 27, 28, 29, 30, 31
.size Ltable, 128
Lcode_end:
.section .rodata,"a"
.p2align 6
.amdhsa_kernel standalone__gqa_block_cached__near_ridge_kernel
  .amdhsa_next_free_vgpr 256
  .amdhsa_next_free_sgpr 102
  .amdhsa_accum_offset 256
  .amdhsa_group_segment_fixed_size 0
  .amdhsa_kernarg_size 64
  .amdhsa_user_sgpr_count 2
  .amdhsa_user_sgpr_kernarg_segment_ptr 1
  .amdhsa_system_sgpr_workgroup_id_x 1
  .amdhsa_float_denorm_mode_32 3
.end_amdhsa_kernel
```
